```python
import torch

def _softmax(x, axis=-1):
    return torch.softmax(x, dim=axis)
def _gelu(x):
    return torch.nn.functional.gelu(x, approximate="tanh")
def _silu(x):
    return torch.nn.functional.silu(x)
def _sigmoid(x):
    return torch.sigmoid(x)
def _layernorm(x, axis=-1, eps=1e-5):
    m = x.mean(dim=axis, keepdim=True)
    v = x.var(dim=axis, keepdim=True, unbiased=False)
    return (x - m) / torch.sqrt(v + eps)
def _scatter_add(tgt, idx, src, axis=0):
    return tgt.clone().index_add_(axis, idx, src)
def _segment_sum(src, seg, n):
    out = torch.zeros((n,) + src.shape[1:], dtype=src.dtype)
    return out.index_add_(0, seg, src)
def _pad(x, pw):
    flat = tuple(v for pair in reversed(pw) for v in pair)
    return torch.nn.functional.pad(x, flat)

kernel_name = 'standalone__gqa_block_cached__near_ridge'

def setup_inputs():

    _w = (lambda a: (lambda t: t.to(torch.bfloat16) if t.is_floating_point() else t)(torch.as_tensor(a)))
    B, Sq, D = 8, 112, 576
    Hq, Hkv, Sk, Dh = 32, 16, 512, 128
    assert Hq % Hkv == 0, (Hq, Hkv)
    return {
        "x": _w((lambda *s: torch.randn(*s, dtype=torch.bfloat16) * 0.8)(B, Sq, D)),
        "k_cache": _w((lambda *s: torch.randn(*s, dtype=torch.bfloat16) * 0.8)(B, Hkv, Sk, Dh)),
        "v_cache": _w((lambda *s: torch.randn(*s, dtype=torch.bfloat16) * 0.05)(B, Hkv, Sk, Dh)),
        "wq": _w((lambda *s: torch.randn(*s, dtype=torch.bfloat16) * 0.8)(D, Hq * Dh) * (D ** -0.5)),
        "wo": _w((lambda *s: torch.randn(*s, dtype=torch.bfloat16) * 0.05)(Hq * Dh, D) * ((Hq * Dh) ** -0.5)),
    }

def reference(x, k_cache, v_cache, wq, wo):
    B, Sq, D = x.shape
    Hq, Dh = 32, 128
    Hkv = k_cache.shape[1]
    rep = Hq // Hkv
    q = (lambda x, *d: x.permute(*d))((x @ wq).reshape(B, Sq, Hq, Dh), 0, 2, 1, 3)
    k = (lambda x, n, axis: torch.repeat_interleave(x, n, dim=axis))(k_cache, rep, axis=1)
    v = (lambda x, n, axis: torch.repeat_interleave(x, n, dim=axis))(v_cache, rep, axis=1)
    scores = torch.einsum("bhqd,bhkd->bhqk", q, k) * (Dh ** -0.5)
    p = _softmax(scores, axis=-1)
    o = torch.einsum("bhqk,bhkd->bhqd", p, v)
    return (lambda x, *d: x.permute(*d))(o, 0, 2, 1, 3).reshape(B, Sq, Hq * Dh) @ wo
```

```asm
; @launch kernel=attn_fused_kernel grid=(256,1,1) block=(512,1,1) lds=163840
; @launch kernel=oproj_kernel grid=(256,1,1) block=(512,1,1) lds=163840
.amdgcn_target "amdgcn-amd-amdhsa--gfx950"
.text
.globl attn_fused_kernel
.p2align 8
.type attn_fused_kernel,@function
attn_fused_kernel:
    s_cmp_ge_u32 s2, 256
    s_cbranch_scc1 K1_END
    s_load_dwordx2 s[96:97], s[0:1], 48
    s_load_dwordx4 s[4:7], s[0:1], 0
    s_load_dwordx4 s[8:11], s[0:1], 16
    s_load_dwordx2 s[12:13], s[0:1], 32
    s_load_dwordx2 s[14:15], s[0:1], 56
    s_and_b32 s50, s2, 7
    s_lshr_b32 s51, s2, 3
    s_lshr_b32 s40, s51, 2
    s_and_b32 s51, s51, 3
    s_lshl_b32 s41, s50, 2
    s_add_u32 s41, s41, s51
    s_lshr_b32 s42, s41, 1
    v_lshrrev_b32 v2, 6, v0
    v_and_b32 v1, 63, v0
    v_readfirstlane_b32 s43, v2
    s_nop 1
    s_and_b32 s58, s43, 3
    s_lshr_b32 s59, s43, 2
    s_lshl_b32 s44, s58, 10
    s_lshl_b32 s45, s40, 4
    s_add_u32 s45, s45, s42
    s_lshl_b32 s45, s45, 17
    s_mul_i32 s53, s40, 112
    s_lshl_b32 s55, s41, 8
    v_lshrrev_b32 v6, 4, v1
    v_and_b32 v7, 15, v1
    s_lshl_b32 s54, s58, 2
    v_add_u32 v56, s54, v6
    v_lshlrev_b32 v57, 2, v6
    v_xor_b32 v57, v7, v57
    v_lshlrev_b32 v57, 4, v57
    v_lshl_add_u32 v9, v56, 13, v57
    v_add_u32 v9, s55, v9
    v_lshl_add_u32 v11, v56, 8, v57
    v_xor_b32 v58, v7, v56
    v_lshlrev_b32 v58, 4, v58
    v_lshl_add_u32 v10, v56, 8, v58
    v_lshrrev_b32 v56, 3, v1
    s_lshl_b32 s54, s58, 3
    v_add_u32 v56, s54, v56
    v_bfe_u32 v57, v56, 1, 3
    v_and_b32 v58, 7, v1
    v_xor_b32 v57, v57, v58
    v_add_u32 v56, s53, v56
    v_mul_u32_u24 v8, 1152, v56
    v_lshl_add_u32 v8, v57, 4, v8
    s_waitcnt lgkmcnt(0)
    s_mov_b32 s16, s4
    s_and_b32 s17, s5, 0xffff
    s_mov_b32 s18, 1032192
    s_mov_b32 s19, 0x00020000
    s_mov_b32 s20, s6
    s_and_b32 s21, s7, 0xffff
    s_mov_b32 s22, 16777216
    s_mov_b32 s23, 0x00020000
    s_mov_b32 s24, s8
    s_and_b32 s25, s9, 0xffff
    s_mov_b32 s26, 16777216
    s_mov_b32 s27, 0x00020000
    s_mov_b32 s28, s10
    s_and_b32 s29, s11, 0xffff
    s_mov_b32 s30, 4718592
    s_mov_b32 s31, 0x00020000
    s_cmp_eq_u32 s59, 0
    s_cbranch_scc0 K1_R1
    s_add_u32 m0, s44, 0
    s_mov_b32 s46, 0
    buffer_load_dwordx4 v9, s[28:31], s46 offen lds
    s_add_u32 m0, s44, 8192
    s_mov_b32 s46, 262144
    buffer_load_dwordx4 v9, s[28:31], s46 offen lds
    s_add_u32 m0, s44, 16384
    s_mov_b32 s46, 0
    buffer_load_dwordx4 v8, s[16:19], s46 offen lds
    s_add_u32 m0, s44, 24576
    s_mov_b32 s46, 73728
    buffer_load_dwordx4 v8, s[16:19], s46 offen lds
    s_add_u32 m0, s44, 32768
    s_mov_b32 s46, 524288
    buffer_load_dwordx4 v9, s[28:31], s46 offen lds
    s_add_u32 m0, s44, 40960
    s_mov_b32 s46, 786432
    buffer_load_dwordx4 v9, s[28:31], s46 offen lds
    s_add_u32 m0, s44, 49152
    s_mov_b32 s46, 128
    buffer_load_dwordx4 v8, s[16:19], s46 offen lds
    s_add_u32 m0, s44, 57344
    s_mov_b32 s46, 73856
    buffer_load_dwordx4 v8, s[16:19], s46 offen lds
    s_add_u32 m0, s44, 65536
    s_mov_b32 s46, 1048576
    buffer_load_dwordx4 v9, s[28:31], s46 offen lds
    s_add_u32 m0, s44, 73728
    s_mov_b32 s46, 1310720
    buffer_load_dwordx4 v9, s[28:31], s46 offen lds
    s_add_u32 m0, s44, 81920
    s_mov_b32 s46, 256
    buffer_load_dwordx4 v8, s[16:19], s46 offen lds
    s_add_u32 m0, s44, 90112
    s_mov_b32 s46, 73984
    buffer_load_dwordx4 v8, s[16:19], s46 offen lds
    s_add_u32 m0, s44, 98304
    s_mov_b32 s46, 1572864
    buffer_load_dwordx4 v9, s[28:31], s46 offen lds
    s_add_u32 m0, s44, 106496
    s_mov_b32 s46, 1835008
    buffer_load_dwordx4 v9, s[28:31], s46 offen lds
    s_add_u32 m0, s44, 114688
    s_mov_b32 s46, 384
    buffer_load_dwordx4 v8, s[16:19], s46 offen lds
    s_add_u32 m0, s44, 122880
    s_mov_b32 s46, 74112
    buffer_load_dwordx4 v8, s[16:19], s46 offen lds
    s_add_u32 m0, s44, 131072
    s_mov_b32 s46, 2097152
    buffer_load_dwordx4 v9, s[28:31], s46 offen lds
    s_add_u32 m0, s44, 139264
    s_mov_b32 s46, 2359296
    buffer_load_dwordx4 v9, s[28:31], s46 offen lds
    s_add_u32 m0, s44, 147456
    s_mov_b32 s46, 512
    buffer_load_dwordx4 v8, s[16:19], s46 offen lds
    s_add_u32 m0, s44, 155648
    s_mov_b32 s46, 74240
    buffer_load_dwordx4 v8, s[16:19], s46 offen lds
K1_R1:
    s_cmp_eq_u32 s59, 1
    s_cbranch_scc0 K1_R2
    s_add_u32 m0, s44, 4096
    s_mov_b32 s46, 131072
    buffer_load_dwordx4 v9, s[28:31], s46 offen lds
    s_add_u32 m0, s44, 12288
    s_mov_b32 s46, 393216
    buffer_load_dwordx4 v9, s[28:31], s46 offen lds
    s_add_u32 m0, s44, 20480
    s_mov_b32 s46, 36864
    buffer_load_dwordx4 v8, s[16:19], s46 offen lds
    s_add_u32 m0, s44, 28672
    s_mov_b32 s46, 110592
    buffer_load_dwordx4 v8, s[16:19], s46 offen lds
    s_add_u32 m0, s44, 36864
    s_mov_b32 s46, 655360
    buffer_load_dwordx4 v9, s[28:31], s46 offen lds
    s_add_u32 m0, s44, 45056
    s_mov_b32 s46, 917504
    buffer_load_dwordx4 v9, s[28:31], s46 offen lds
    s_add_u32 m0, s44, 53248
    s_mov_b32 s46, 36992
    buffer_load_dwordx4 v8, s[16:19], s46 offen lds
    s_add_u32 m0, s44, 61440
    s_mov_b32 s46, 110720
    buffer_load_dwordx4 v8, s[16:19], s46 offen lds
    s_add_u32 m0, s44, 69632
    s_mov_b32 s46, 1179648
    buffer_load_dwordx4 v9, s[28:31], s46 offen lds
    s_add_u32 m0, s44, 77824
    s_mov_b32 s46, 1441792
    buffer_load_dwordx4 v9, s[28:31], s46 offen lds
    s_add_u32 m0, s44, 86016
    s_mov_b32 s46, 37120
    buffer_load_dwordx4 v8, s[16:19], s46 offen lds
    s_add_u32 m0, s44, 94208
    s_mov_b32 s46, 110848
    buffer_load_dwordx4 v8, s[16:19], s46 offen lds
    s_add_u32 m0, s44, 102400
    s_mov_b32 s46, 1703936
    buffer_load_dwordx4 v9, s[28:31], s46 offen lds
    s_add_u32 m0, s44, 110592
    s_mov_b32 s46, 1966080
    buffer_load_dwordx4 v9, s[28:31], s46 offen lds
    s_add_u32 m0, s44, 118784
    s_mov_b32 s46, 37248
    buffer_load_dwordx4 v8, s[16:19], s46 offen lds
    s_add_u32 m0, s44, 126976
    s_mov_b32 s46, 110976
    buffer_load_dwordx4 v8, s[16:19], s46 offen lds
    s_add_u32 m0, s44, 135168
    s_mov_b32 s46, 2228224
    buffer_load_dwordx4 v9, s[28:31], s46 offen lds
    s_add_u32 m0, s44, 143360
    s_mov_b32 s46, 2490368
    buffer_load_dwordx4 v9, s[28:31], s46 offen lds
    s_add_u32 m0, s44, 151552
    s_mov_b32 s46, 37376
    buffer_load_dwordx4 v8, s[16:19], s46 offen lds
    s_add_u32 m0, s44, 159744
    s_mov_b32 s46, 111104
    buffer_load_dwordx4 v8, s[16:19], s46 offen lds
K1_R2:
    s_mov_b32 s32, s12
    s_and_b32 s33, s13, 0xffff
    s_mov_b32 s34, 4718592
    s_mov_b32 s35, 0x00020000
    s_mov_b32 s36, s14
    s_and_b32 s37, s15, 0xffff
    s_mov_b32 s38, 7340032
    s_mov_b32 s39, 0x00020000
    s_nop 4
    s_mov_b32 s47, 0x3e0293ee
    s_mov_b32 s48, 0x427af233
    s_mov_b32 s52, 0xbe0293ee
    s_mov_b32 s49, 0
    v_and_b32 v3, 31, v1
    v_lshrrev_b32 v4, 5, v1
    v_bfe_u32 v5, v1, 4, 1
    v_lshlrev_b32 v12, 17, v5
    v_lshl_add_u32 v12, v4, 8, v12
    v_and_b32 v5, 15, v1
    v_lshl_add_u32 v12, v5, 4, v12
    s_mul_i32 s54, s40, 7
    s_lshl_b32 s57, s58, 1
    s_add_u32 s54, s54, s57
    s_lshl_b32 s54, s54, 17
    s_lshl_b32 s57, s41, 12
    s_add_u32 s54, s54, s57
    s_lshl_b32 s57, s59, 11
    s_add_u32 s54, s54, s57
    v_add_u32 v12, s54, v12
    v_bfe_u32 v56, v1, 4, 1
    v_bfe_u32 v57, v1, 2, 2
    v_and_b32 v58, 1, v1
    v_bfe_u32 v59, v1, 1, 1
    v_lshl_add_u32 v60, v4, 5, v57
    v_lshlrev_b32 v60, 8, v60
    v_lshl_add_u32 v60, v56, 5, v60
    v_lshl_add_u32 v60, v58, 4, v60
    v_lshl_add_u32 v60, v59, 3, v60
    s_lshl_b32 s54, s59, 1
    v_xor_b32 v57, s54, v57
    s_lshl_b32 s56, s59, 14
    v_xor_b32 v2, 0, v57
    v_lshl_add_u32 v44, v2, 6, v60
    v_add_u32 v48, 0x10000, v44
    v_add_u32 v52, 0x20000, v44
    v_xor_b32 v2, 1, v57
    v_lshl_add_u32 v45, v2, 6, v60
    v_add_u32 v49, 0x10000, v45
    v_add_u32 v53, 0x20000, v45
    v_xor_b32 v2, 2, v57
    v_lshl_add_u32 v46, v2, 6, v60
    v_add_u32 v50, 0x10000, v46
    v_add_u32 v54, 0x20000, v46
    v_xor_b32 v2, 3, v57
    v_lshl_add_u32 v47, v2, 6, v60
    v_add_u32 v51, 0x10000, v47
    v_add_u32 v55, 0x20000, v47
    s_lshl_b32 s54, s58, 5
    v_add_u32 v56, s54, v3
    v_bfe_u32 v57, v56, 1, 3
    v_lshlrev_b32 v56, 7, v56
    v_add_u32 v56, 0x4000, v56
    v_lshl_add_u32 v2, v4, 2, 0
    v_xor_b32 v2, v2, v57
    v_lshl_add_u32 v112, v2, 4, v56
    v_add_u32 v116, 0x10000, v112
    v_add_u32 v120, 0x20000, v112
    v_lshl_add_u32 v2, v4, 2, 1
    v_xor_b32 v2, v2, v57
    v_lshl_add_u32 v113, v2, 4, v56
    v_add_u32 v117, 0x10000, v113
    v_add_u32 v121, 0x20000, v113
    v_lshl_add_u32 v2, v4, 2, 2
    v_xor_b32 v2, v2, v57
    v_lshl_add_u32 v114, v2, 4, v56
    v_add_u32 v118, 0x10000, v114
    v_add_u32 v122, 0x20000, v114
    v_lshl_add_u32 v2, v4, 2, 3
    v_xor_b32 v2, v2, v57
    v_lshl_add_u32 v115, v2, 4, v56
    v_add_u32 v119, 0x10000, v115
    v_add_u32 v123, 0x20000, v115
    v_bfe_u32 v2, v1, 2, 1
    v_bfe_u32 v56, v1, 3, 1
    v_bfe_u32 v57, v1, 4, 1
    v_and_b32 v58, 3, v1
    v_lshl_add_u32 v58, v56, 2, v58
    v_lshl_add_u32 v58, v57, 3, v58
    v_lshl_add_u32 v59, v2, 5, v58
    v_lshlrev_b32 v59, 8, v59
    v_add_u32 v59, s56, v59
    s_lshl_b32 s54, s59, 3
    v_xor_b32 v58, s54, v58
    v_add_u32 v2, 0, v4
    v_xor_b32 v2, v2, v58
    v_lshl_add_u32 v20, v2, 4, v59
    v_add_u32 v28, 0x10000, v20
    v_add_u32 v36, 0x20000, v20
    v_add_u32 v2, 2, v4
    v_xor_b32 v2, v2, v58
    v_lshl_add_u32 v21, v2, 4, v59
    v_add_u32 v29, 0x10000, v21
    v_add_u32 v37, 0x20000, v21
    v_add_u32 v2, 4, v4
    v_xor_b32 v2, v2, v58
    v_lshl_add_u32 v22, v2, 4, v59
    v_add_u32 v30, 0x10000, v22
    v_add_u32 v38, 0x20000, v22
    v_add_u32 v2, 6, v4
    v_xor_b32 v2, v2, v58
    v_lshl_add_u32 v23, v2, 4, v59
    v_add_u32 v31, 0x10000, v23
    v_add_u32 v39, 0x20000, v23
    v_add_u32 v2, 8, v4
    v_xor_b32 v2, v2, v58
    v_lshl_add_u32 v24, v2, 4, v59
    v_add_u32 v32, 0x10000, v24
    v_add_u32 v40, 0x20000, v24
    v_add_u32 v2, 10, v4
    v_xor_b32 v2, v2, v58
    v_lshl_add_u32 v25, v2, 4, v59
    v_add_u32 v33, 0x10000, v25
    v_add_u32 v41, 0x20000, v25
    v_add_u32 v2, 12, v4
    v_xor_b32 v2, v2, v58
    v_lshl_add_u32 v26, v2, 4, v59
    v_add_u32 v34, 0x10000, v26
    v_add_u32 v42, 0x20000, v26
    v_add_u32 v2, 14, v4
    v_xor_b32 v2, v2, v58
    v_lshl_add_u32 v27, v2, 4, v59
    v_add_u32 v35, 0x10000, v27
    v_add_u32 v43, 0x20000, v27
    s_cmp_eq_u32 s59, 0
    s_cbranch_scc0 K1_R3
    s_waitcnt vmcnt(16)
K1_R3:
    s_cmp_eq_u32 s59, 1
    s_cbranch_scc0 K1_R4
    s_waitcnt vmcnt(16)
K1_R4:
    s_barrier
    ds_read_b128 a[32:35], v112 offset:0
    ds_read_b64_tr_b16 a[96:97], v44 offset:0
    ds_read_b64_tr_b16 a[98:99], v44 offset:1024
    ds_read_b64_tr_b16 a[100:101], v45 offset:0
    ds_read_b64_tr_b16 a[102:103], v45 offset:1024
    ds_read_b128 a[36:39], v113 offset:0
    ds_read_b64_tr_b16 a[104:105], v44 offset:2048
    ds_read_b64_tr_b16 a[106:107], v44 offset:3072
    ds_read_b64_tr_b16 a[108:109], v45 offset:2048
    ds_read_b64_tr_b16 a[110:111], v45 offset:3072
    s_waitcnt lgkmcnt(7)
    v_mfma_f32_32x32x16_bf16 v[64:79], a[96:99], a[32:35], 0
    ds_read_b128 a[40:43], v114 offset:0
    ds_read_b64_tr_b16 a[112:113], v44 offset:4096
    ds_read_b64_tr_b16 a[114:115], v44 offset:5120
    s_waitcnt lgkmcnt(8)
    v_mfma_f32_32x32x16_bf16 v[80:95], a[100:103], a[32:35], 0
    ds_read_b64_tr_b16 a[116:117], v45 offset:4096
    ds_read_b64_tr_b16 a[118:119], v45 offset:5120
    s_waitcnt lgkmcnt(7)
    v_mfma_f32_32x32x16_bf16 v[64:79], a[104:107], a[36:39], v[64:79]
    ds_read_b128 a[44:47], v115 offset:0
    ds_read_b64_tr_b16 a[96:97], v44 offset:6144
    ds_read_b64_tr_b16 a[98:99], v44 offset:7168
    s_waitcnt lgkmcnt(8)
    v_mfma_f32_32x32x16_bf16 v[80:95], a[108:111], a[36:39], v[80:95]
    ds_read_b64_tr_b16 a[100:101], v45 offset:6144
    ds_read_b64_tr_b16 a[102:103], v45 offset:7168
    s_waitcnt lgkmcnt(7)
    v_mfma_f32_32x32x16_bf16 v[64:79], a[112:115], a[40:43], v[64:79]
    s_cmp_eq_u32 s59, 0
    s_cbranch_scc0 K1_R5
    s_waitcnt vmcnt(12)
K1_R5:
    s_cmp_eq_u32 s59, 1
    s_cbranch_scc0 K1_R6
    s_waitcnt vmcnt(12)
K1_R6:
    s_barrier
    ds_read_b128 a[32:35], v112 offset:32768
    ds_read_b64_tr_b16 a[104:105], v44 offset:32768
    ds_read_b64_tr_b16 a[106:107], v44 offset:33792
    s_waitcnt lgkmcnt(8)
    v_mfma_f32_32x32x16_bf16 v[80:95], a[116:119], a[40:43], v[80:95]
    ds_read_b64_tr_b16 a[108:109], v45 offset:32768
    ds_read_b64_tr_b16 a[110:111], v45 offset:33792
    s_waitcnt lgkmcnt(7)
    v_mfma_f32_32x32x16_bf16 v[64:79], a[96:99], a[44:47], v[64:79]
    ds_read_b128 a[36:39], v113 offset:32768
    ds_read_b64_tr_b16 a[112:113], v44 offset:34816
    ds_read_b64_tr_b16 a[114:115], v44 offset:35840
    s_waitcnt lgkmcnt(8)
    v_mfma_f32_32x32x16_bf16 v[80:95], a[100:103], a[44:47], v[80:95]
    ds_read_b64_tr_b16 a[116:117], v45 offset:34816
    ds_read_b64_tr_b16 a[118:119], v45 offset:35840
    s_waitcnt lgkmcnt(7)
    v_mfma_f32_32x32x16_bf16 v[64:79], a[104:107], a[32:35], v[64:79]
    ds_read_b128 a[40:43], v114 offset:32768
    ds_read_b64_tr_b16 a[96:97], v44 offset:36864
    ds_read_b64_tr_b16 a[98:99], v44 offset:37888
    s_waitcnt lgkmcnt(8)
    v_mfma_f32_32x32x16_bf16 v[80:95], a[108:111], a[32:35], v[80:95]
    ds_read_b64_tr_b16 a[100:101], v45 offset:36864
    ds_read_b64_tr_b16 a[102:103], v45 offset:37888
    s_waitcnt lgkmcnt(7)
    v_mfma_f32_32x32x16_bf16 v[64:79], a[112:115], a[36:39], v[64:79]
    ds_read_b128 a[44:47], v115 offset:32768
    ds_read_b64_tr_b16 a[104:105], v44 offset:38912
    ds_read_b64_tr_b16 a[106:107], v44 offset:39936
    s_waitcnt lgkmcnt(8)
    v_mfma_f32_32x32x16_bf16 v[80:95], a[116:119], a[36:39], v[80:95]
    ds_read_b64_tr_b16 a[108:109], v45 offset:38912
    ds_read_b64_tr_b16 a[110:111], v45 offset:39936
    s_waitcnt lgkmcnt(7)
    v_mfma_f32_32x32x16_bf16 v[64:79], a[96:99], a[40:43], v[64:79]
    s_cmp_eq_u32 s59, 0
    s_cbranch_scc0 K1_R7
    s_waitcnt vmcnt(8)
K1_R7:
    s_cmp_eq_u32 s59, 1
    s_cbranch_scc0 K1_R8
    s_waitcnt vmcnt(8)
K1_R8:
    s_barrier
    s_cmp_eq_u32 s59, 0
    s_cbranch_scc0 K1_R9
    s_add_u32 m0, s44, 0
    s_mov_b32 s46, 2621440
    buffer_load_dwordx4 v9, s[28:31], s46 offen lds
    s_add_u32 m0, s44, 4096
    s_mov_b32 s46, 2752512
    buffer_load_dwordx4 v9, s[28:31], s46 offen lds
    s_add_u32 m0, s44, 8192
    s_mov_b32 s46, 2883584
    buffer_load_dwordx4 v9, s[28:31], s46 offen lds
    s_add_u32 m0, s44, 12288
    s_mov_b32 s46, 3014656
    buffer_load_dwordx4 v9, s[28:31], s46 offen lds
    s_add_u32 m0, s44, 16384
    s_mov_b32 s46, 640
    buffer_load_dwordx4 v8, s[16:19], s46 offen lds
    s_add_u32 m0, s44, 20480
    s_mov_b32 s46, 37504
    buffer_load_dwordx4 v8, s[16:19], s46 offen lds
    s_add_u32 m0, s44, 24576
    s_mov_b32 s46, 74368
    buffer_load_dwordx4 v8, s[16:19], s46 offen lds
    s_add_u32 m0, s44, 28672
    s_mov_b32 s46, 111232
    buffer_load_dwordx4 v8, s[16:19], s46 offen lds
K1_R9:
    ds_read_b128 a[32:35], v116 offset:0
    ds_read_b64_tr_b16 a[112:113], v48 offset:0
    ds_read_b64_tr_b16 a[114:115], v48 offset:1024
    s_waitcnt lgkmcnt(8)
    v_mfma_f32_32x32x16_bf16 v[80:95], a[100:103], a[40:43], v[80:95]
    ds_read_b64_tr_b16 a[116:117], v49 offset:0
    ds_read_b64_tr_b16 a[118:119], v49 offset:1024
    s_waitcnt lgkmcnt(7)
    v_mfma_f32_32x32x16_bf16 v[64:79], a[104:107], a[44:47], v[64:79]
    ds_read_b128 a[36:39], v117 offset:0
    ds_read_b64_tr_b16 a[96:97], v48 offset:2048
    ds_read_b64_tr_b16 a[98:99], v48 offset:3072
    s_waitcnt lgkmcnt(8)
    v_mfma_f32_32x32x16_bf16 v[80:95], a[108:111], a[44:47], v[80:95]
    ds_read_b64_tr_b16 a[100:101], v49 offset:2048
    ds_read_b64_tr_b16 a[102:103], v49 offset:3072
    s_waitcnt lgkmcnt(7)
    v_mfma_f32_32x32x16_bf16 v[64:79], a[112:115], a[32:35], v[64:79]
    ds_read_b128 a[40:43], v118 offset:0
    ds_read_b64_tr_b16 a[104:105], v48 offset:4096
    ds_read_b64_tr_b16 a[106:107], v48 offset:5120
    s_waitcnt lgkmcnt(8)
    v_mfma_f32_32x32x16_bf16 v[80:95], a[116:119], a[32:35], v[80:95]
    ds_read_b64_tr_b16 a[108:109], v49 offset:4096
    ds_read_b64_tr_b16 a[110:111], v49 offset:5120
    s_waitcnt lgkmcnt(7)
    v_mfma_f32_32x32x16_bf16 v[64:79], a[96:99], a[36:39], v[64:79]
    ds_read_b128 a[44:47], v119 offset:0
    ds_read_b64_tr_b16 a[112:113], v48 offset:6144
    ds_read_b64_tr_b16 a[114:115], v48 offset:7168
    s_waitcnt lgkmcnt(8)
    v_mfma_f32_32x32x16_bf16 v[80:95], a[100:103], a[36:39], v[80:95]
    ds_read_b64_tr_b16 a[116:117], v49 offset:6144
    ds_read_b64_tr_b16 a[118:119], v49 offset:7168
    s_waitcnt lgkmcnt(7)
    v_mfma_f32_32x32x16_bf16 v[64:79], a[104:107], a[40:43], v[64:79]
    s_cmp_eq_u32 s59, 0
    s_cbranch_scc0 K1_R10
    s_waitcnt vmcnt(12)
K1_R10:
    s_cmp_eq_u32 s59, 1
    s_cbranch_scc0 K1_R11
    s_waitcnt vmcnt(4)
K1_R11:
    s_barrier
    s_cmp_eq_u32 s59, 0
    s_cbranch_scc0 K1_R12
    s_add_u32 m0, s44, 32768
    s_mov_b32 s46, 3145728
    buffer_load_dwordx4 v9, s[28:31], s46 offen lds
    s_add_u32 m0, s44, 36864
    s_mov_b32 s46, 3276800
    buffer_load_dwordx4 v9, s[28:31], s46 offen lds
    s_add_u32 m0, s44, 40960
    s_mov_b32 s46, 3407872
    buffer_load_dwordx4 v9, s[28:31], s46 offen lds
    s_add_u32 m0, s44, 45056
    s_mov_b32 s46, 3538944
    buffer_load_dwordx4 v9, s[28:31], s46 offen lds
    s_add_u32 m0, s44, 49152
    s_mov_b32 s46, 768
    buffer_load_dwordx4 v8, s[16:19], s46 offen lds
    s_add_u32 m0, s44, 53248
    s_mov_b32 s46, 37632
    buffer_load_dwordx4 v8, s[16:19], s46 offen lds
    s_add_u32 m0, s44, 57344
    s_mov_b32 s46, 74496
    buffer_load_dwordx4 v8, s[16:19], s46 offen lds
    s_add_u32 m0, s44, 61440
    s_mov_b32 s46, 111360
    buffer_load_dwordx4 v8, s[16:19], s46 offen lds
K1_R12:
    ds_read_b128 a[32:35], v116 offset:32768
    ds_read_b64_tr_b16 a[96:97], v48 offset:32768
    ds_read_b64_tr_b16 a[98:99], v48 offset:33792
    s_waitcnt lgkmcnt(8)
    v_mfma_f32_32x32x16_bf16 v[80:95], a[108:111], a[40:43], v[80:95]
    ds_read_b64_tr_b16 a[100:101], v49 offset:32768
    ds_read_b64_tr_b16 a[102:103], v49 offset:33792
    s_waitcnt lgkmcnt(7)
    v_mfma_f32_32x32x16_bf16 v[64:79], a[112:115], a[44:47], v[64:79]
    ds_read_b128 a[36:39], v117 offset:32768
    ds_read_b64_tr_b16 a[104:105], v48 offset:34816
    ds_read_b64_tr_b16 a[106:107], v48 offset:35840
    s_waitcnt lgkmcnt(8)
    v_mfma_f32_32x32x16_bf16 v[80:95], a[116:119], a[44:47], v[80:95]
    ds_read_b64_tr_b16 a[108:109], v49 offset:34816
    ds_read_b64_tr_b16 a[110:111], v49 offset:35840
    s_waitcnt lgkmcnt(7)
    v_mfma_f32_32x32x16_bf16 v[64:79], a[96:99], a[32:35], v[64:79]
    ds_read_b128 a[40:43], v118 offset:32768
    ds_read_b64_tr_b16 a[112:113], v48 offset:36864
    ds_read_b64_tr_b16 a[114:115], v48 offset:37888
    s_waitcnt lgkmcnt(8)
    v_mfma_f32_32x32x16_bf16 v[80:95], a[100:103], a[32:35], v[80:95]
    ds_read_b64_tr_b16 a[116:117], v49 offset:36864
    ds_read_b64_tr_b16 a[118:119], v49 offset:37888
    s_waitcnt lgkmcnt(7)
    v_mfma_f32_32x32x16_bf16 v[64:79], a[104:107], a[36:39], v[64:79]
    ds_read_b128 a[44:47], v119 offset:32768
    ds_read_b64_tr_b16 a[96:97], v48 offset:38912
    ds_read_b64_tr_b16 a[98:99], v48 offset:39936
    s_waitcnt lgkmcnt(8)
    v_mfma_f32_32x32x16_bf16 v[80:95], a[108:111], a[36:39], v[80:95]
    ds_read_b64_tr_b16 a[100:101], v49 offset:38912
    ds_read_b64_tr_b16 a[102:103], v49 offset:39936
    s_waitcnt lgkmcnt(7)
    v_mfma_f32_32x32x16_bf16 v[64:79], a[112:115], a[40:43], v[64:79]
    s_cmp_eq_u32 s59, 0
    s_cbranch_scc0 K1_R13
    s_waitcnt vmcnt(16)
K1_R13:
    s_cmp_eq_u32 s59, 1
    s_cbranch_scc0 K1_R14
    s_waitcnt vmcnt(0)
K1_R14:
    s_barrier
    s_cmp_eq_u32 s59, 0
    s_cbranch_scc0 K1_R15
    s_add_u32 m0, s44, 65536
    s_mov_b32 s46, 3670016
    buffer_load_dwordx4 v9, s[28:31], s46 offen lds
    s_add_u32 m0, s44, 69632
    s_mov_b32 s46, 3801088
    buffer_load_dwordx4 v9, s[28:31], s46 offen lds
    s_add_u32 m0, s44, 73728
    s_mov_b32 s46, 3932160
    buffer_load_dwordx4 v9, s[28:31], s46 offen lds
    s_add_u32 m0, s44, 77824
    s_mov_b32 s46, 4063232
    buffer_load_dwordx4 v9, s[28:31], s46 offen lds
    s_add_u32 m0, s44, 81920
    s_mov_b32 s46, 896
    buffer_load_dwordx4 v8, s[16:19], s46 offen lds
    s_add_u32 m0, s44, 86016
    s_mov_b32 s46, 37760
    buffer_load_dwordx4 v8, s[16:19], s46 offen lds
    s_add_u32 m0, s44, 90112
    s_mov_b32 s46, 74624
    buffer_load_dwordx4 v8, s[16:19], s46 offen lds
    s_add_u32 m0, s44, 94208
    s_mov_b32 s46, 111488
    buffer_load_dwordx4 v8, s[16:19], s46 offen lds
K1_R15:
    ds_read_b128 a[32:35], v120 offset:0
    ds_read_b64_tr_b16 a[104:105], v52 offset:0
    ds_read_b64_tr_b16 a[106:107], v52 offset:1024
    s_waitcnt lgkmcnt(8)
    v_mfma_f32_32x32x16_bf16 v[80:95], a[116:119], a[40:43], v[80:95]
    ds_read_b64_tr_b16 a[108:109], v53 offset:0
    ds_read_b64_tr_b16 a[110:111], v53 offset:1024
    s_waitcnt lgkmcnt(7)
    v_mfma_f32_32x32x16_bf16 v[64:79], a[96:99], a[44:47], v[64:79]
    ds_read_b128 a[36:39], v121 offset:0
    ds_read_b64_tr_b16 a[112:113], v52 offset:2048
    ds_read_b64_tr_b16 a[114:115], v52 offset:3072
    s_waitcnt lgkmcnt(8)
    v_mfma_f32_32x32x16_bf16 v[80:95], a[100:103], a[44:47], v[80:95]
    ds_read_b64_tr_b16 a[116:117], v53 offset:2048
    ds_read_b64_tr_b16 a[118:119], v53 offset:3072
    s_waitcnt lgkmcnt(7)
    v_mfma_f32_32x32x16_bf16 v[64:79], a[104:107], a[32:35], v[64:79]
    ds_read_b128 a[40:43], v122 offset:0
    ds_read_b64_tr_b16 a[96:97], v52 offset:4096
    ds_read_b64_tr_b16 a[98:99], v52 offset:5120
    s_waitcnt lgkmcnt(8)
    v_mfma_f32_32x32x16_bf16 v[80:95], a[108:111], a[32:35], v[80:95]
    ds_read_b64_tr_b16 a[100:101], v53 offset:4096
    ds_read_b64_tr_b16 a[102:103], v53 offset:5120
    s_waitcnt lgkmcnt(7)
    v_mfma_f32_32x32x16_bf16 v[64:79], a[112:115], a[36:39], v[64:79]
    ds_read_b128 a[44:47], v123 offset:0
    ds_read_b64_tr_b16 a[104:105], v52 offset:6144
    ds_read_b64_tr_b16 a[106:107], v52 offset:7168
    s_waitcnt lgkmcnt(8)
    v_mfma_f32_32x32x16_bf16 v[80:95], a[116:119], a[36:39], v[80:95]
    ds_read_b64_tr_b16 a[108:109], v53 offset:6144
    ds_read_b64_tr_b16 a[110:111], v53 offset:7168
    s_waitcnt lgkmcnt(7)
    v_mfma_f32_32x32x16_bf16 v[64:79], a[96:99], a[40:43], v[64:79]
    s_cmp_eq_u32 s59, 0
    s_cbranch_scc0 K1_R16
    s_waitcnt vmcnt(16)
K1_R16:
    s_barrier
    s_cmp_eq_u32 s59, 0
    s_cbranch_scc0 K1_R17
    s_add_u32 m0, s44, 98304
    s_mov_b32 s46, 4194304
    buffer_load_dwordx4 v9, s[28:31], s46 offen lds
    s_add_u32 m0, s44, 102400
    s_mov_b32 s46, 4325376
    buffer_load_dwordx4 v9, s[28:31], s46 offen lds
    s_add_u32 m0, s44, 106496
    s_mov_b32 s46, 4456448
    buffer_load_dwordx4 v9, s[28:31], s46 offen lds
    s_add_u32 m0, s44, 110592
    s_mov_b32 s46, 4587520
    buffer_load_dwordx4 v9, s[28:31], s46 offen lds
    s_add_u32 m0, s44, 114688
    s_mov_b32 s46, 1024
    buffer_load_dwordx4 v8, s[16:19], s46 offen lds
    s_add_u32 m0, s44, 118784
    s_mov_b32 s46, 37888
    buffer_load_dwordx4 v8, s[16:19], s46 offen lds
    s_add_u32 m0, s44, 122880
    s_mov_b32 s46, 74752
    buffer_load_dwordx4 v8, s[16:19], s46 offen lds
    s_add_u32 m0, s44, 126976
    s_mov_b32 s46, 111616
    buffer_load_dwordx4 v8, s[16:19], s46 offen lds
K1_R17:
    ds_read_b128 a[32:35], v112 offset:0
    ds_read_b64_tr_b16 a[112:113], v44 offset:0
    ds_read_b64_tr_b16 a[114:115], v44 offset:1024
    s_waitcnt lgkmcnt(8)
    v_mfma_f32_32x32x16_bf16 v[80:95], a[100:103], a[40:43], v[80:95]
    ds_read_b64_tr_b16 a[116:117], v45 offset:0
    ds_read_b64_tr_b16 a[118:119], v45 offset:1024
    s_waitcnt lgkmcnt(7)
    v_mfma_f32_32x32x16_bf16 v[64:79], a[104:107], a[44:47], v[64:79]
    ds_read_b128 a[36:39], v113 offset:0
    ds_read_b64_tr_b16 a[96:97], v44 offset:2048
    ds_read_b64_tr_b16 a[98:99], v44 offset:3072
    s_waitcnt lgkmcnt(8)
    v_mfma_f32_32x32x16_bf16 v[80:95], a[108:111], a[44:47], v[80:95]
    ds_read_b64_tr_b16 a[100:101], v45 offset:2048
    ds_read_b64_tr_b16 a[102:103], v45 offset:3072
    s_waitcnt lgkmcnt(7)
    v_mfma_f32_32x32x16_bf16 v[64:79], a[112:115], a[32:35], v[64:79]
    ds_read_b128 a[40:43], v114 offset:0
    ds_read_b64_tr_b16 a[104:105], v44 offset:4096
    ds_read_b64_tr_b16 a[106:107], v44 offset:5120
    s_waitcnt lgkmcnt(8)
    v_mfma_f32_32x32x16_bf16 v[80:95], a[116:119], a[32:35], v[80:95]
    ds_read_b64_tr_b16 a[108:109], v45 offset:4096
    ds_read_b64_tr_b16 a[110:111], v45 offset:5120
    s_waitcnt lgkmcnt(7)
    v_mfma_f32_32x32x16_bf16 v[64:79], a[96:99], a[36:39], v[64:79]
    ds_read_b128 a[44:47], v115 offset:0
    ds_read_b64_tr_b16 a[112:113], v44 offset:6144
    ds_read_b64_tr_b16 a[114:115], v44 offset:7168
    s_waitcnt lgkmcnt(8)
    v_mfma_f32_32x32x16_bf16 v[80:95], a[100:103], a[36:39], v[80:95]
    ds_read_b64_tr_b16 a[116:117], v45 offset:6144
    ds_read_b64_tr_b16 a[118:119], v45 offset:7168
    s_waitcnt lgkmcnt(7)
    v_mfma_f32_32x32x16_bf16 v[64:79], a[104:107], a[40:43], v[64:79]
    s_cmp_eq_u32 s59, 0
    s_cbranch_scc0 K1_R18
    s_waitcnt vmcnt(16)
K1_R18:
    s_barrier
    s_cmp_eq_u32 s59, 1
    s_cbranch_scc0 K1_R19
    s_add_u32 m0, s44, 131072
    s_add_u32 s46, s45, 0
    buffer_load_dwordx4 v10, s[20:23], s46 offen nt lds
    s_add_u32 m0, s44, 135168
    s_add_u32 s46, s45, 4096
    buffer_load_dwordx4 v10, s[20:23], s46 offen nt lds
    s_add_u32 m0, s44, 139264
    s_add_u32 s46, s45, 8192
    buffer_load_dwordx4 v10, s[20:23], s46 offen nt lds
    s_add_u32 m0, s44, 143360
    s_add_u32 s46, s45, 12288
    buffer_load_dwordx4 v10, s[20:23], s46 offen nt lds
    s_add_u32 m0, s44, 147456
    s_add_u32 s46, s45, 16384
    buffer_load_dwordx4 v10, s[20:23], s46 offen nt lds
    s_add_u32 m0, s44, 151552
    s_add_u32 s46, s45, 20480
    buffer_load_dwordx4 v10, s[20:23], s46 offen nt lds
    s_add_u32 m0, s44, 155648
    s_add_u32 s46, s45, 24576
    buffer_load_dwordx4 v10, s[20:23], s46 offen nt lds
    s_add_u32 m0, s44, 159744
    s_add_u32 s46, s45, 28672
    buffer_load_dwordx4 v10, s[20:23], s46 offen nt lds
K1_R19:
    ds_read_b128 a[32:35], v112 offset:32768
    ds_read_b64_tr_b16 a[96:97], v44 offset:32768
    ds_read_b64_tr_b16 a[98:99], v44 offset:33792
    s_waitcnt lgkmcnt(8)
    v_mfma_f32_32x32x16_bf16 v[80:95], a[108:111], a[40:43], v[80:95]
    ds_read_b64_tr_b16 a[100:101], v45 offset:32768
    ds_read_b64_tr_b16 a[102:103], v45 offset:33792
    s_waitcnt lgkmcnt(7)
    v_mfma_f32_32x32x16_bf16 v[64:79], a[112:115], a[44:47], v[64:79]
    ds_read_b128 a[36:39], v113 offset:32768
    ds_read_b64_tr_b16 a[104:105], v44 offset:34816
    ds_read_b64_tr_b16 a[106:107], v44 offset:35840
    s_waitcnt lgkmcnt(8)
    v_mfma_f32_32x32x16_bf16 v[80:95], a[116:119], a[44:47], v[80:95]
    ds_read_b64_tr_b16 a[108:109], v45 offset:34816
    ds_read_b64_tr_b16 a[110:111], v45 offset:35840
    s_waitcnt lgkmcnt(7)
    v_mfma_f32_32x32x16_bf16 v[64:79], a[96:99], a[32:35], v[64:79]
    ds_read_b128 a[40:43], v114 offset:32768
    ds_read_b64_tr_b16 a[112:113], v44 offset:36864
    ds_read_b64_tr_b16 a[114:115], v44 offset:37888
    s_waitcnt lgkmcnt(8)
    v_mfma_f32_32x32x16_bf16 v[80:95], a[100:103], a[32:35], v[80:95]
    ds_read_b64_tr_b16 a[116:117], v45 offset:36864
    ds_read_b64_tr_b16 a[118:119], v45 offset:37888
    s_waitcnt lgkmcnt(7)
    v_mfma_f32_32x32x16_bf16 v[64:79], a[104:107], a[36:39], v[64:79]
    ds_read_b128 a[44:47], v115 offset:32768
    ds_read_b64_tr_b16 a[96:97], v44 offset:38912
    ds_read_b64_tr_b16 a[98:99], v44 offset:39936
    s_waitcnt lgkmcnt(8)
    v_mfma_f32_32x32x16_bf16 v[80:95], a[108:111], a[36:39], v[80:95]
    ds_read_b64_tr_b16 a[100:101], v45 offset:38912
    ds_read_b64_tr_b16 a[102:103], v45 offset:39936
    s_waitcnt lgkmcnt(7)
    v_mfma_f32_32x32x16_bf16 v[64:79], a[112:115], a[40:43], v[64:79]
    s_cmp_eq_u32 s59, 0
    s_cbranch_scc0 K1_R20
    s_waitcnt vmcnt(8)
K1_R20:
    s_barrier
    s_cmp_eq_u32 s59, 1
    s_cbranch_scc0 K1_R21
    s_add_u32 m0, s44, 0
    s_add_u32 s46, s45, 32768
    buffer_load_dwordx4 v10, s[20:23], s46 offen nt lds
    s_add_u32 m0, s44, 4096
    s_add_u32 s46, s45, 36864
    buffer_load_dwordx4 v10, s[20:23], s46 offen nt lds
    s_add_u32 m0, s44, 8192
    s_add_u32 s46, s45, 40960
    buffer_load_dwordx4 v10, s[20:23], s46 offen nt lds
    s_add_u32 m0, s44, 12288
    s_add_u32 s46, s45, 45056
    buffer_load_dwordx4 v10, s[20:23], s46 offen nt lds
    s_add_u32 m0, s44, 16384
    s_add_u32 s46, s45, 49152
    buffer_load_dwordx4 v10, s[20:23], s46 offen nt lds
    s_add_u32 m0, s44, 20480
    s_add_u32 s46, s45, 53248
    buffer_load_dwordx4 v10, s[20:23], s46 offen nt lds
    s_add_u32 m0, s44, 24576
    s_add_u32 s46, s45, 57344
    buffer_load_dwordx4 v10, s[20:23], s46 offen nt lds
    s_add_u32 m0, s44, 28672
    s_add_u32 s46, s45, 61440
    buffer_load_dwordx4 v10, s[20:23], s46 offen nt lds
K1_R21:
    ds_read_b128 a[32:35], v116 offset:0
    ds_read_b64_tr_b16 a[104:105], v48 offset:0
    ds_read_b64_tr_b16 a[106:107], v48 offset:1024
    s_waitcnt lgkmcnt(8)
    v_mfma_f32_32x32x16_bf16 v[80:95], a[116:119], a[40:43], v[80:95]
    ds_read_b64_tr_b16 a[108:109], v49 offset:0
    ds_read_b64_tr_b16 a[110:111], v49 offset:1024
    s_waitcnt lgkmcnt(7)
    v_mfma_f32_32x32x16_bf16 v[64:79], a[96:99], a[44:47], v[64:79]
    ds_read_b128 a[36:39], v117 offset:0
    ds_read_b64_tr_b16 a[112:113], v48 offset:2048
    ds_read_b64_tr_b16 a[114:115], v48 offset:3072
    s_waitcnt lgkmcnt(8)
    v_mfma_f32_32x32x16_bf16 v[80:95], a[100:103], a[44:47], v[80:95]
    ds_read_b64_tr_b16 a[116:117], v49 offset:2048
    ds_read_b64_tr_b16 a[118:119], v49 offset:3072
    s_waitcnt lgkmcnt(7)
    v_mfma_f32_32x32x16_bf16 v[64:79], a[104:107], a[32:35], v[64:79]
    ds_read_b128 a[40:43], v118 offset:0
    ds_read_b64_tr_b16 a[96:97], v48 offset:4096
    ds_read_b64_tr_b16 a[98:99], v48 offset:5120
    s_waitcnt lgkmcnt(8)
    v_mfma_f32_32x32x16_bf16 v[80:95], a[108:111], a[32:35], v[80:95]
    ds_read_b64_tr_b16 a[100:101], v49 offset:4096
    ds_read_b64_tr_b16 a[102:103], v49 offset:5120
    s_waitcnt lgkmcnt(7)
    v_mfma_f32_32x32x16_bf16 v[64:79], a[112:115], a[36:39], v[64:79]
    ds_read_b128 a[44:47], v119 offset:0
    ds_read_b64_tr_b16 a[104:105], v48 offset:6144
    ds_read_b64_tr_b16 a[106:107], v48 offset:7168
    s_waitcnt lgkmcnt(8)
    v_mfma_f32_32x32x16_bf16 v[80:95], a[116:119], a[36:39], v[80:95]
    ds_read_b64_tr_b16 a[108:109], v49 offset:6144
    ds_read_b64_tr_b16 a[110:111], v49 offset:7168
    s_waitcnt lgkmcnt(7)
    v_mfma_f32_32x32x16_bf16 v[64:79], a[96:99], a[40:43], v[64:79]
    s_cmp_eq_u32 s59, 0
    s_cbranch_scc0 K1_R22
    s_waitcnt vmcnt(0)
K1_R22:
    s_barrier
    ds_read_b128 a[32:35], v116 offset:32768
    ds_read_b64_tr_b16 a[112:113], v48 offset:32768
    ds_read_b64_tr_b16 a[114:115], v48 offset:33792
    s_waitcnt lgkmcnt(8)
    v_mfma_f32_32x32x16_bf16 v[80:95], a[100:103], a[40:43], v[80:95]
    ds_read_b64_tr_b16 a[116:117], v49 offset:32768
    ds_read_b64_tr_b16 a[118:119], v49 offset:33792
    s_waitcnt lgkmcnt(7)
    v_mfma_f32_32x32x16_bf16 v[64:79], a[104:107], a[44:47], v[64:79]
    ds_read_b128 a[36:39], v117 offset:32768
    ds_read_b64_tr_b16 a[96:97], v48 offset:34816
    ds_read_b64_tr_b16 a[98:99], v48 offset:35840
    s_waitcnt lgkmcnt(8)
    v_mfma_f32_32x32x16_bf16 v[80:95], a[108:111], a[44:47], v[80:95]
    ds_read_b64_tr_b16 a[100:101], v49 offset:34816
    ds_read_b64_tr_b16 a[102:103], v49 offset:35840
    s_waitcnt lgkmcnt(7)
    v_mfma_f32_32x32x16_bf16 v[64:79], a[112:115], a[32:35], v[64:79]
    ds_read_b128 a[40:43], v118 offset:32768
    ds_read_b64_tr_b16 a[104:105], v48 offset:36864
    ds_read_b64_tr_b16 a[106:107], v48 offset:37888
    s_waitcnt lgkmcnt(8)
    v_mfma_f32_32x32x16_bf16 v[80:95], a[116:119], a[32:35], v[80:95]
    ds_read_b64_tr_b16 a[108:109], v49 offset:36864
    ds_read_b64_tr_b16 a[110:111], v49 offset:37888
    s_waitcnt lgkmcnt(7)
    v_mfma_f32_32x32x16_bf16 v[64:79], a[96:99], a[36:39], v[64:79]
    ds_read_b128 a[44:47], v119 offset:32768
    ds_read_b64_tr_b16 a[112:113], v48 offset:38912
    ds_read_b64_tr_b16 a[114:115], v48 offset:39936
    s_waitcnt lgkmcnt(8)
    v_mfma_f32_32x32x16_bf16 v[80:95], a[100:103], a[36:39], v[80:95]
    ds_read_b64_tr_b16 a[116:117], v49 offset:38912
    ds_read_b64_tr_b16 a[118:119], v49 offset:39936
    s_waitcnt lgkmcnt(7)
    v_mfma_f32_32x32x16_bf16 v[64:79], a[104:107], a[40:43], v[64:79]
    s_cmp_eq_u32 s59, 1
    s_cbranch_scc0 K1_R23
    s_waitcnt vmcnt(8)
K1_R23:
    s_barrier
    s_cmp_eq_u32 s59, 0
    s_cbranch_scc0 K1_R24
    s_add_u32 m0, s44, 65536
    s_add_u32 s46, s45, 0
    buffer_load_dwordx4 v11, s[24:27], s46 offen nt lds
    s_add_u32 m0, s44, 69632
    s_add_u32 s46, s45, 4096
    buffer_load_dwordx4 v11, s[24:27], s46 offen nt lds
    s_add_u32 m0, s44, 73728
    s_add_u32 s46, s45, 8192
    buffer_load_dwordx4 v11, s[24:27], s46 offen nt lds
    s_add_u32 m0, s44, 77824
    s_add_u32 s46, s45, 12288
    buffer_load_dwordx4 v11, s[24:27], s46 offen nt lds
    s_add_u32 m0, s44, 81920
    s_add_u32 s46, s45, 16384
    buffer_load_dwordx4 v11, s[24:27], s46 offen nt lds
    s_add_u32 m0, s44, 86016
    s_add_u32 s46, s45, 20480
    buffer_load_dwordx4 v11, s[24:27], s46 offen nt lds
    s_add_u32 m0, s44, 90112
    s_add_u32 s46, s45, 24576
    buffer_load_dwordx4 v11, s[24:27], s46 offen nt lds
    s_add_u32 m0, s44, 94208
    s_add_u32 s46, s45, 28672
    buffer_load_dwordx4 v11, s[24:27], s46 offen nt lds
K1_R24:
    ds_read_b128 a[96:99], v36 offset:0
    s_waitcnt lgkmcnt(6)
    v_mfma_f32_32x32x16_bf16 v[80:95], a[108:111], a[40:43], v[80:95]
    ds_read_b128 a[100:103], v37 offset:0
    s_waitcnt lgkmcnt(4)
    v_mfma_f32_32x32x16_bf16 v[64:79], a[112:115], a[44:47], v[64:79]
    ds_read_b128 a[104:107], v38 offset:0
    s_waitcnt lgkmcnt(3)
    v_mfma_f32_32x32x16_bf16 v[80:95], a[116:119], a[44:47], v[80:95]
    s_nop 7
    s_nop 3
    v_cvt_pk_bf16_f32 v96, v64, v65
    v_cvt_pk_bf16_f32 v97, v66, v67
    v_cvt_pk_bf16_f32 v98, v68, v69
    v_cvt_pk_bf16_f32 v99, v70, v71
    v_cvt_pk_bf16_f32 v100, v72, v73
    v_cvt_pk_bf16_f32 v101, v74, v75
    v_cvt_pk_bf16_f32 v102, v76, v77
    v_cvt_pk_bf16_f32 v103, v78, v79
    v_cvt_pk_bf16_f32 v104, v80, v81
    v_cvt_pk_bf16_f32 v105, v82, v83
    v_cvt_pk_bf16_f32 v106, v84, v85
    v_cvt_pk_bf16_f32 v107, v86, v87
    v_cvt_pk_bf16_f32 v108, v88, v89
    v_cvt_pk_bf16_f32 v109, v90, v91
    v_cvt_pk_bf16_f32 v110, v92, v93
    v_cvt_pk_bf16_f32 v111, v94, v95
    s_lshl_b32 s54, s58, 13
    s_lshl_b32 s57, s59, 12
    v_lshlrev_b32 v5, 4, v1
    v_add_u32 v5, s54, v5
    v_add_u32 v5, 32768, v5
    v_add_u32 v6, s57, v5
    v_xor_b32 v7, 0x1000, v6
    ds_write_b128 v6, v[96:99] offset:0
    ds_write_b128 v6, v[100:103] offset:1024
    ds_write_b128 v6, v[104:107] offset:2048
    ds_write_b128 v6, v[108:111] offset:3072
    v_add_u32 v44, s56, v44
    v_add_u32 v45, s56, v45
    v_add_u32 v46, s56, v46
    v_add_u32 v47, s56, v47
    v_add_u32 v48, s56, v48
    v_add_u32 v49, s56, v49
    v_add_u32 v50, s56, v50
    v_add_u32 v51, s56, v51
    v_add_u32 v52, s56, v52
    v_add_u32 v53, s56, v53
    v_add_u32 v54, s56, v54
    v_add_u32 v55, s56, v55
    ds_read_b128 a[108:111], v39 offset:0
    s_waitcnt lgkmcnt(7)
    v_mfma_f32_32x32x16_bf16 v[64:79], a[96:99], v[96:99], 0
    ds_read_b128 a[112:115], v36 offset:4096
    s_waitcnt lgkmcnt(7)
    v_mfma_f32_32x32x16_bf16 v[64:79], a[100:103], v[100:103], v[64:79]
    ds_read_b128 a[116:119], v37 offset:4096
    s_waitcnt lgkmcnt(7)
    v_mfma_f32_32x32x16_bf16 v[64:79], a[104:107], v[104:107], v[64:79]
    ds_read_b128 a[96:99], v38 offset:4096
    s_waitcnt lgkmcnt(3)
    v_mfma_f32_32x32x16_bf16 v[64:79], a[108:111], v[108:111], v[64:79]
    ds_read_b128 a[100:103], v39 offset:4096
    s_waitcnt lgkmcnt(3)
    v_mfma_f32_32x32x16_bf16 v[80:95], a[112:115], v[96:99], 0
    ds_read_b128 a[104:107], v40 offset:0
    s_waitcnt lgkmcnt(3)
    v_mfma_f32_32x32x16_bf16 v[80:95], a[116:119], v[100:103], v[80:95]
    ds_read_b128 a[108:111], v41 offset:0
    s_waitcnt lgkmcnt(3)
    v_mfma_f32_32x32x16_bf16 v[80:95], a[96:99], v[104:107], v[80:95]
    ds_read_b128 a[112:115], v42 offset:0
    s_waitcnt lgkmcnt(3)
    v_mfma_f32_32x32x16_bf16 v[80:95], a[100:103], v[108:111], v[80:95]
    s_waitcnt lgkmcnt(8)
    s_barrier
    s_cmp_eq_u32 s59, 0
    s_cbranch_scc0 K1_R25
    s_add_u32 m0, s44, 98304
    s_add_u32 s46, s45, 65536
    buffer_load_dwordx4 v10, s[20:23], s46 offen nt lds
    s_add_u32 m0, s44, 102400
    s_add_u32 s46, s45, 69632
    buffer_load_dwordx4 v10, s[20:23], s46 offen nt lds
    s_add_u32 m0, s44, 106496
    s_add_u32 s46, s45, 73728
    buffer_load_dwordx4 v10, s[20:23], s46 offen nt lds
    s_add_u32 m0, s44, 110592
    s_add_u32 s46, s45, 77824
    buffer_load_dwordx4 v10, s[20:23], s46 offen nt lds
    s_add_u32 m0, s44, 114688
    s_add_u32 s46, s45, 81920
    buffer_load_dwordx4 v10, s[20:23], s46 offen nt lds
    s_add_u32 m0, s44, 118784
    s_add_u32 s46, s45, 86016
    buffer_load_dwordx4 v10, s[20:23], s46 offen nt lds
    s_add_u32 m0, s44, 122880
    s_add_u32 s46, s45, 90112
    buffer_load_dwordx4 v10, s[20:23], s46 offen nt lds
    s_add_u32 m0, s44, 126976
    s_add_u32 s46, s45, 94208
    buffer_load_dwordx4 v10, s[20:23], s46 offen nt lds
K1_R25:
    ds_read_b128 a[80:83], v7 offset:0
    ds_read_b128 a[84:87], v7 offset:1024
    ds_read_b128 a[88:91], v7 offset:2048
    ds_read_b128 a[92:95], v7 offset:3072
    ds_read_b128 a[64:67], v6 offset:0
    ds_read_b128 a[68:71], v6 offset:1024
    ds_read_b128 a[72:75], v6 offset:2048
    ds_read_b128 a[76:79], v6 offset:3072
    s_waitcnt lgkmcnt(4)
    ds_read_b128 a[116:119], v43 offset:0
    s_waitcnt lgkmcnt(11)
    v_mfma_f32_32x32x16_bf16 v[64:79], a[104:107], a[80:83], v[64:79]
    ds_read_b128 a[96:99], v40 offset:4096
    s_waitcnt lgkmcnt(11)
    v_mfma_f32_32x32x16_bf16 v[64:79], a[108:111], a[84:87], v[64:79]
    ds_read_b128 a[100:103], v41 offset:4096
    s_waitcnt lgkmcnt(11)
    v_mfma_f32_32x32x16_bf16 v[64:79], a[112:115], a[88:91], v[64:79]
    ds_read_b128 a[104:107], v42 offset:4096
    s_waitcnt lgkmcnt(3)
    v_mfma_f32_32x32x16_bf16 v[64:79], a[116:119], a[92:95], v[64:79]
    ds_read_b128 a[108:111], v43 offset:4096
    s_waitcnt lgkmcnt(3)
    v_mfma_f32_32x32x16_bf16 v[80:95], a[96:99], a[80:83], v[80:95]
    s_cmp_eq_u32 s59, 1
    s_cbranch_scc0 K1_R26
    s_waitcnt vmcnt(0)
K1_R26:
    s_barrier
    s_cmp_eq_u32 s59, 1
    s_cbranch_scc0 K1_R27
    s_add_u32 m0, s44, 32768
    s_add_u32 s46, s45, 32768
    buffer_load_dwordx4 v11, s[24:27], s46 offen nt lds
    s_add_u32 m0, s44, 36864
    s_add_u32 s46, s45, 36864
    buffer_load_dwordx4 v11, s[24:27], s46 offen nt lds
    s_add_u32 m0, s44, 40960
    s_add_u32 s46, s45, 40960
    buffer_load_dwordx4 v11, s[24:27], s46 offen nt lds
    s_add_u32 m0, s44, 45056
    s_add_u32 s46, s45, 45056
    buffer_load_dwordx4 v11, s[24:27], s46 offen nt lds
    s_add_u32 m0, s44, 49152
    s_add_u32 s46, s45, 49152
    buffer_load_dwordx4 v11, s[24:27], s46 offen nt lds
    s_add_u32 m0, s44, 53248
    s_add_u32 s46, s45, 53248
    buffer_load_dwordx4 v11, s[24:27], s46 offen nt lds
    s_add_u32 m0, s44, 57344
    s_add_u32 s46, s45, 57344
    buffer_load_dwordx4 v11, s[24:27], s46 offen nt lds
    s_add_u32 m0, s44, 61440
    s_add_u32 s46, s45, 61440
    buffer_load_dwordx4 v11, s[24:27], s46 offen nt lds
K1_R27:
    ds_read_b128 a[112:115], v20 offset:0
    s_waitcnt lgkmcnt(3)
    v_mfma_f32_32x32x16_bf16 v[80:95], a[100:103], a[84:87], v[80:95]
    ds_read_b128 a[116:119], v21 offset:0
    s_waitcnt lgkmcnt(3)
    v_mfma_f32_32x32x16_bf16 v[80:95], a[104:107], a[88:91], v[80:95]
    ds_read_b128 a[96:99], v22 offset:0
    s_waitcnt lgkmcnt(3)
    v_mfma_f32_32x32x16_bf16 v[80:95], a[108:111], a[92:95], v[80:95]
    ds_read_b128 a[100:103], v23 offset:0
    s_waitcnt lgkmcnt(3)
    v_mfma_f32_32x32x16_bf16 v[96:111], a[112:115], a[64:67], 0
    ds_read_b128 a[104:107], v24 offset:0
    s_waitcnt lgkmcnt(3)
    v_mfma_f32_32x32x16_bf16 v[96:111], a[116:119], a[68:71], v[96:111]
    v_max3_f32 v2, v64, v65, v66
    v_max3_f32 v2, v2, v67, v68
    v_max3_f32 v2, v2, v69, v70
    v_max3_f32 v2, v2, v71, v72
    v_max3_f32 v2, v2, v73, v74
    v_max3_f32 v2, v2, v75, v76
    v_max3_f32 v2, v2, v77, v78
    v_max_f32 v2, v2, v79
    v_max3_f32 v3, v80, v81, v82
    ds_read_b128 a[108:111], v25 offset:0
    s_waitcnt lgkmcnt(3)
    v_mfma_f32_32x32x16_bf16 v[96:111], a[96:99], a[72:75], v[96:111]
    v_max3_f32 v3, v3, v83, v84
    v_max3_f32 v3, v3, v85, v86
    v_max3_f32 v3, v3, v87, v88
    v_max3_f32 v3, v3, v89, v90
    v_max3_f32 v3, v3, v91, v92
    v_max3_f32 v3, v3, v93, v94
    v_max_f32 v3, v3, v95
    v_max_f32 v2, v2, v3
    v_mov_b32 v3, v2
    s_nop 1
    v_permlane32_swap_b32 v3, v2
    v_max_f32 v2, v2, v3
    v_mov_b32 v13, v2
    v_mul_f32 v14, s52, v2
    v_mov_b32 v16, 0
    v_mov_b32 v17, 0
    v_mov_b32 v18, 0
    v_mov_b32 v19, 0
    ds_read_b128 a[112:115], v26 offset:0
    s_waitcnt lgkmcnt(3)
    v_mfma_f32_32x32x16_bf16 v[96:111], a[100:103], a[76:79], v[96:111]
    v_fma_f32 v64, v64, s47, v14
    v_fma_f32 v65, v65, s47, v14
    v_fma_f32 v66, v66, s47, v14
    v_fma_f32 v67, v67, s47, v14
    v_exp_f32 v64, v64
    v_exp_f32 v65, v65
    v_exp_f32 v66, v66
    v_exp_f32 v67, v67
    ds_read_b128 a[116:119], v27 offset:0
    s_waitcnt lgkmcnt(3)
    v_mfma_f32_32x32x16_bf16 v[96:111], a[104:107], a[80:83], v[96:111]
    v_add_f32 v16, v16, v64
    v_add_f32 v17, v17, v65
    v_add_f32 v18, v18, v66
    v_add_f32 v19, v19, v67
    v_cvt_pk_bf16_f32 v64, v64, v65
    v_cvt_pk_bf16_f32 v65, v66, v67
    v_fma_f32 v68, v68, s47, v14
    v_fma_f32 v69, v69, s47, v14
    v_fma_f32 v70, v70, s47, v14
    ds_read_b128 a[96:99], v20 offset:4096
    s_waitcnt lgkmcnt(3)
    v_mfma_f32_32x32x16_bf16 v[96:111], a[108:111], a[84:87], v[96:111]
    v_fma_f32 v71, v71, s47, v14
    v_exp_f32 v68, v68
    v_exp_f32 v69, v69
    v_exp_f32 v70, v70
    v_exp_f32 v71, v71
    v_add_f32 v16, v16, v68
    v_add_f32 v17, v17, v69
    v_add_f32 v18, v18, v70
    v_add_f32 v19, v19, v71
    ds_read_b128 a[100:103], v21 offset:4096
    s_waitcnt lgkmcnt(3)
    v_mfma_f32_32x32x16_bf16 v[96:111], a[112:115], a[88:91], v[96:111]
    v_cvt_pk_bf16_f32 v66, v68, v69
    v_cvt_pk_bf16_f32 v67, v70, v71
    v_fma_f32 v72, v72, s47, v14
    v_fma_f32 v73, v73, s47, v14
    v_fma_f32 v74, v74, s47, v14
    v_fma_f32 v75, v75, s47, v14
    v_exp_f32 v72, v72
    v_exp_f32 v73, v73
    ds_read_b128 a[104:107], v22 offset:4096
    s_waitcnt lgkmcnt(3)
    v_mfma_f32_32x32x16_bf16 v[96:111], a[116:119], a[92:95], v[96:111]
    v_exp_f32 v74, v74
    v_exp_f32 v75, v75
    v_add_f32 v16, v16, v72
    v_add_f32 v17, v17, v73
    v_add_f32 v18, v18, v74
    v_add_f32 v19, v19, v75
    v_cvt_pk_bf16_f32 v72, v72, v73
    v_cvt_pk_bf16_f32 v73, v74, v75
    v_fma_f32 v76, v76, s47, v14
    ds_read_b128 a[108:111], v23 offset:4096
    s_waitcnt lgkmcnt(3)
    v_mfma_f32_32x32x16_bf16 v[112:127], a[96:99], a[64:67], 0
    v_fma_f32 v77, v77, s47, v14
    v_fma_f32 v78, v78, s47, v14
    v_fma_f32 v79, v79, s47, v14
    v_exp_f32 v76, v76
    v_exp_f32 v77, v77
    v_exp_f32 v78, v78
    v_exp_f32 v79, v79
    v_add_f32 v16, v16, v76
    v_add_f32 v17, v17, v77
    ds_read_b128 a[112:115], v24 offset:4096
    s_waitcnt lgkmcnt(3)
    v_mfma_f32_32x32x16_bf16 v[112:127], a[100:103], a[68:71], v[112:127]
    v_add_f32 v18, v18, v78
    v_add_f32 v19, v19, v79
    v_cvt_pk_bf16_f32 v74, v76, v77
    v_cvt_pk_bf16_f32 v75, v78, v79
    v_fma_f32 v80, v80, s47, v14
    v_fma_f32 v81, v81, s47, v14
    v_fma_f32 v82, v82, s47, v14
    v_fma_f32 v83, v83, s47, v14
    ds_read_b128 a[116:119], v25 offset:4096
    s_waitcnt lgkmcnt(3)
    v_mfma_f32_32x32x16_bf16 v[112:127], a[104:107], a[72:75], v[112:127]
    v_exp_f32 v80, v80
    v_exp_f32 v81, v81
    v_exp_f32 v82, v82
    v_exp_f32 v83, v83
    v_add_f32 v16, v16, v80
    v_add_f32 v17, v17, v81
    v_add_f32 v18, v18, v82
    v_add_f32 v19, v19, v83
    v_cvt_pk_bf16_f32 v80, v80, v81
    ds_read_b128 a[96:99], v26 offset:4096
    s_waitcnt lgkmcnt(3)
    v_mfma_f32_32x32x16_bf16 v[112:127], a[108:111], a[76:79], v[112:127]
    v_cvt_pk_bf16_f32 v81, v82, v83
    v_fma_f32 v84, v84, s47, v14
    v_fma_f32 v85, v85, s47, v14
    v_fma_f32 v86, v86, s47, v14
    v_fma_f32 v87, v87, s47, v14
    v_exp_f32 v84, v84
    v_exp_f32 v85, v85
    v_exp_f32 v86, v86
    v_exp_f32 v87, v87
    ds_read_b128 a[100:103], v27 offset:4096
    s_waitcnt lgkmcnt(3)
    v_mfma_f32_32x32x16_bf16 v[112:127], a[112:115], a[80:83], v[112:127]
    v_add_f32 v16, v16, v84
    v_add_f32 v17, v17, v85
    v_add_f32 v18, v18, v86
    v_add_f32 v19, v19, v87
    v_cvt_pk_bf16_f32 v82, v84, v85
    v_cvt_pk_bf16_f32 v83, v86, v87
    v_fma_f32 v88, v88, s47, v14
    v_fma_f32 v89, v89, s47, v14
    s_cmp_eq_u32 s59, 0
    s_cbranch_scc0 K1_R28
    s_waitcnt vmcnt(8)
K1_R28:
    s_barrier
    s_cmp_eq_u32 s59, 0
    s_cbranch_scc0 K1_R29
    s_add_u32 m0, s44, 131072
    s_add_u32 s46, s45, 98304
    buffer_load_dwordx4 v10, s[20:23], s46 offen nt lds
    s_add_u32 m0, s44, 135168
    s_add_u32 s46, s45, 102400
    buffer_load_dwordx4 v10, s[20:23], s46 offen nt lds
    s_add_u32 m0, s44, 139264
    s_add_u32 s46, s45, 106496
    buffer_load_dwordx4 v10, s[20:23], s46 offen nt lds
    s_add_u32 m0, s44, 143360
    s_add_u32 s46, s45, 110592
    buffer_load_dwordx4 v10, s[20:23], s46 offen nt lds
    s_add_u32 m0, s44, 147456
    s_add_u32 s46, s45, 114688
    buffer_load_dwordx4 v10, s[20:23], s46 offen nt lds
    s_add_u32 m0, s44, 151552
    s_add_u32 s46, s45, 118784
    buffer_load_dwordx4 v10, s[20:23], s46 offen nt lds
    s_add_u32 m0, s44, 155648
    s_add_u32 s46, s45, 122880
    buffer_load_dwordx4 v10, s[20:23], s46 offen nt lds
    s_add_u32 m0, s44, 159744
    s_add_u32 s46, s45, 126976
    buffer_load_dwordx4 v10, s[20:23], s46 offen nt lds
K1_R29:
    ds_read_b64_tr_b16 a[104:105], v48 offset:0
    ds_read_b64_tr_b16 a[106:107], v48 offset:1024
    s_waitcnt lgkmcnt(4)
    v_mfma_f32_32x32x16_bf16 v[112:127], a[116:119], a[84:87], v[112:127]
    v_fma_f32 v90, v90, s47, v14
    v_fma_f32 v91, v91, s47, v14
    v_exp_f32 v88, v88
    v_exp_f32 v89, v89
    v_exp_f32 v90, v90
    v_exp_f32 v91, v91
    v_add_f32 v16, v16, v88
    v_add_f32 v17, v17, v89
    v_add_f32 v18, v18, v90
    ds_read_b64_tr_b16 a[108:109], v49 offset:0
    ds_read_b64_tr_b16 a[110:111], v49 offset:1024
    s_waitcnt lgkmcnt(5)
    v_mfma_f32_32x32x16_bf16 v[112:127], a[96:99], a[88:91], v[112:127]
    v_add_f32 v19, v19, v91
    v_cvt_pk_bf16_f32 v88, v88, v89
    v_cvt_pk_bf16_f32 v89, v90, v91
    v_fma_f32 v92, v92, s47, v14
    v_fma_f32 v93, v93, s47, v14
    v_fma_f32 v94, v94, s47, v14
    v_fma_f32 v95, v95, s47, v14
    v_exp_f32 v92, v92
    v_exp_f32 v93, v93
    ds_read_b64_tr_b16 a[112:113], v50 offset:0
    ds_read_b64_tr_b16 a[114:115], v50 offset:1024
    s_waitcnt lgkmcnt(6)
    v_mfma_f32_32x32x16_bf16 v[112:127], a[100:103], a[92:95], v[112:127]
    v_exp_f32 v94, v94
    v_exp_f32 v95, v95
    v_add_f32 v16, v16, v92
    v_add_f32 v17, v17, v93
    v_add_f32 v18, v18, v94
    v_add_f32 v19, v19, v95
    v_cvt_pk_bf16_f32 v90, v92, v93
    v_cvt_pk_bf16_f32 v91, v94, v95
    ds_read_b64_tr_b16 a[116:117], v51 offset:0
    ds_read_b64_tr_b16 a[118:119], v51 offset:1024
    s_waitcnt lgkmcnt(6)
    v_mfma_f32_32x32x16_bf16 a[0:15], a[104:107], v[64:67], 0
    ds_read_b64_tr_b16 a[96:97], v48 offset:2048
    ds_read_b64_tr_b16 a[98:99], v48 offset:3072
    s_waitcnt lgkmcnt(6)
    v_mfma_f32_32x32x16_bf16 a[16:31], a[108:111], v[64:67], 0
    v_max3_f32 v2, v96, v97, v98
    v_max3_f32 v2, v2, v99, v100
    v_max3_f32 v2, v2, v101, v102
    v_max3_f32 v2, v2, v103, v104
    v_max3_f32 v2, v2, v105, v106
    ds_read_b64_tr_b16 a[100:101], v49 offset:2048
    ds_read_b64_tr_b16 a[102:103], v49 offset:3072
    s_waitcnt lgkmcnt(6)
    v_mfma_f32_32x32x16_bf16 a[32:47], a[112:115], v[64:67], 0
    v_max3_f32 v2, v2, v107, v108
    v_max3_f32 v2, v2, v109, v110
    v_max_f32 v2, v2, v111
    v_max3_f32 v3, v112, v113, v114
    ds_read_b64_tr_b16 a[104:105], v50 offset:2048
    ds_read_b64_tr_b16 a[106:107], v50 offset:3072
    s_waitcnt lgkmcnt(6)
    v_mfma_f32_32x32x16_bf16 a[48:63], a[116:119], v[64:67], 0
    v_max3_f32 v3, v3, v115, v116
    v_max3_f32 v3, v3, v117, v118
    v_max3_f32 v3, v3, v119, v120
    v_max3_f32 v3, v3, v121, v122
    ds_read_b64_tr_b16 a[108:109], v51 offset:2048
    ds_read_b64_tr_b16 a[110:111], v51 offset:3072
    s_waitcnt lgkmcnt(6)
    v_mfma_f32_32x32x16_bf16 a[0:15], a[96:99], v[72:75], a[0:15]
    v_max3_f32 v3, v3, v123, v124
    v_max3_f32 v3, v3, v125, v126
    v_max_f32 v3, v3, v127
    v_max_f32 v2, v2, v3
    ds_read_b64_tr_b16 a[112:113], v48 offset:4096
    ds_read_b64_tr_b16 a[114:115], v48 offset:5120
    s_waitcnt lgkmcnt(6)
    v_mfma_f32_32x32x16_bf16 a[16:31], a[100:103], v[72:75], a[16:31]
    v_mov_b32 v3, v2
    s_nop 1
    v_permlane32_swap_b32 v3, v2
    v_max_f32 v2, v2, v3
    v_sub_f32 v3, v2, v13
    v_cmp_lt_f32 vcc, s48, v3
    s_cbranch_vccnz K1_UPD1
K1_UPDR1:
    v_fma_f32 v96, v96, s47, v14
    v_fma_f32 v97, v97, s47, v14
    v_fma_f32 v98, v98, s47, v14
    ds_read_b64_tr_b16 a[116:117], v49 offset:4096
    ds_read_b64_tr_b16 a[118:119], v49 offset:5120
    s_waitcnt lgkmcnt(6)
    v_mfma_f32_32x32x16_bf16 a[32:47], a[104:107], v[72:75], a[32:47]
    v_fma_f32 v99, v99, s47, v14
    v_exp_f32 v96, v96
    v_exp_f32 v97, v97
    v_exp_f32 v98, v98
    v_exp_f32 v99, v99
    ds_read_b64_tr_b16 a[96:97], v50 offset:4096
    ds_read_b64_tr_b16 a[98:99], v50 offset:5120
    s_waitcnt lgkmcnt(6)
    v_mfma_f32_32x32x16_bf16 a[48:63], a[108:111], v[72:75], a[48:63]
    v_add_f32 v16, v16, v96
    v_add_f32 v17, v17, v97
    v_add_f32 v18, v18, v98
    v_add_f32 v19, v19, v99
    ds_read_b64_tr_b16 a[100:101], v51 offset:4096
    ds_read_b64_tr_b16 a[102:103], v51 offset:5120
    s_waitcnt lgkmcnt(6)
    v_mfma_f32_32x32x16_bf16 a[0:15], a[112:115], v[80:83], a[0:15]
    v_cvt_pk_bf16_f32 v96, v96, v97
    v_cvt_pk_bf16_f32 v97, v98, v99
    v_fma_f32 v100, v100, s47, v14
    v_fma_f32 v101, v101, s47, v14
    ds_read_b64_tr_b16 a[104:105], v48 offset:6144
    ds_read_b64_tr_b16 a[106:107], v48 offset:7168
    s_waitcnt lgkmcnt(6)
    v_mfma_f32_32x32x16_bf16 a[16:31], a[116:119], v[80:83], a[16:31]
    v_fma_f32 v102, v102, s47, v14
    v_fma_f32 v103, v103, s47, v14
    v_exp_f32 v100, v100
    v_exp_f32 v101, v101
    ds_read_b64_tr_b16 a[108:109], v49 offset:6144
    ds_read_b64_tr_b16 a[110:111], v49 offset:7168
    s_waitcnt lgkmcnt(6)
    v_mfma_f32_32x32x16_bf16 a[32:47], a[96:99], v[80:83], a[32:47]
    v_exp_f32 v102, v102
    v_exp_f32 v103, v103
    v_add_f32 v16, v16, v100
    v_add_f32 v17, v17, v101
    ds_read_b64_tr_b16 a[112:113], v50 offset:6144
    ds_read_b64_tr_b16 a[114:115], v50 offset:7168
    s_waitcnt lgkmcnt(6)
    v_mfma_f32_32x32x16_bf16 a[48:63], a[100:103], v[80:83], a[48:63]
    v_add_f32 v18, v18, v102
    v_add_f32 v19, v19, v103
    v_cvt_pk_bf16_f32 v98, v100, v101
    v_cvt_pk_bf16_f32 v99, v102, v103
    v_fma_f32 v104, v104, s47, v14
    ds_read_b64_tr_b16 a[116:117], v51 offset:6144
    ds_read_b64_tr_b16 a[118:119], v51 offset:7168
    s_waitcnt lgkmcnt(6)
    v_mfma_f32_32x32x16_bf16 a[0:15], a[104:107], v[88:91], a[0:15]
    v_fma_f32 v105, v105, s47, v14
    v_fma_f32 v106, v106, s47, v14
    v_fma_f32 v107, v107, s47, v14
    v_exp_f32 v104, v104
    s_cmp_eq_u32 s59, 0
    s_cbranch_scc0 K1_R30
    s_waitcnt vmcnt(8)
K1_R30:
    s_barrier
    s_cmp_eq_u32 s59, 1
    s_cbranch_scc0 K1_R31
    s_add_u32 m0, s44, 0
    s_add_u32 s46, s45, 65536
    buffer_load_dwordx4 v11, s[24:27], s46 offen nt lds
    s_add_u32 m0, s44, 4096
    s_add_u32 s46, s45, 69632
    buffer_load_dwordx4 v11, s[24:27], s46 offen nt lds
    s_add_u32 m0, s44, 8192
    s_add_u32 s46, s45, 73728
    buffer_load_dwordx4 v11, s[24:27], s46 offen nt lds
    s_add_u32 m0, s44, 12288
    s_add_u32 s46, s45, 77824
    buffer_load_dwordx4 v11, s[24:27], s46 offen nt lds
    s_add_u32 m0, s44, 16384
    s_add_u32 s46, s45, 81920
    buffer_load_dwordx4 v11, s[24:27], s46 offen nt lds
    s_add_u32 m0, s44, 20480
    s_add_u32 s46, s45, 86016
    buffer_load_dwordx4 v11, s[24:27], s46 offen nt lds
    s_add_u32 m0, s44, 24576
    s_add_u32 s46, s45, 90112
    buffer_load_dwordx4 v11, s[24:27], s46 offen nt lds
    s_add_u32 m0, s44, 28672
    s_add_u32 s46, s45, 94208
    buffer_load_dwordx4 v11, s[24:27], s46 offen nt lds
K1_R31:
    ds_read_b128 a[96:99], v28 offset:32768
    s_waitcnt lgkmcnt(5)
    v_mfma_f32_32x32x16_bf16 a[16:31], a[108:111], v[88:91], a[16:31]
    v_exp_f32 v105, v105
    v_exp_f32 v106, v106
    v_exp_f32 v107, v107
    v_add_f32 v16, v16, v104
    ds_read_b128 a[100:103], v29 offset:32768
    s_waitcnt lgkmcnt(4)
    v_mfma_f32_32x32x16_bf16 a[32:47], a[112:115], v[88:91], a[32:47]
    v_add_f32 v17, v17, v105
    v_add_f32 v18, v18, v106
    v_add_f32 v19, v19, v107
    v_cvt_pk_bf16_f32 v104, v104, v105
    ds_read_b128 a[104:107], v30 offset:32768
    s_waitcnt lgkmcnt(3)
    v_mfma_f32_32x32x16_bf16 a[48:63], a[116:119], v[88:91], a[48:63]
    v_cvt_pk_bf16_f32 v105, v106, v107
    v_fma_f32 v108, v108, s47, v14
    v_fma_f32 v109, v109, s47, v14
    v_fma_f32 v110, v110, s47, v14
    ds_read_b128 a[108:111], v31 offset:32768
    s_waitcnt lgkmcnt(3)
    v_mfma_f32_32x32x16_bf16 v[64:79], a[96:99], a[64:67], 0
    v_fma_f32 v111, v111, s47, v14
    v_exp_f32 v108, v108
    v_exp_f32 v109, v109
    v_exp_f32 v110, v110
    v_exp_f32 v111, v111
    ds_read_b128 a[112:115], v32 offset:32768
    s_waitcnt lgkmcnt(3)
    v_mfma_f32_32x32x16_bf16 v[64:79], a[100:103], a[68:71], v[64:79]
    v_add_f32 v16, v16, v108
    v_add_f32 v17, v17, v109
    v_add_f32 v18, v18, v110
    v_add_f32 v19, v19, v111
    ds_read_b128 a[116:119], v33 offset:32768
    s_waitcnt lgkmcnt(3)
    v_mfma_f32_32x32x16_bf16 v[64:79], a[104:107], a[72:75], v[64:79]
    v_cvt_pk_bf16_f32 v106, v108, v109
    v_cvt_pk_bf16_f32 v107, v110, v111
    v_fma_f32 v112, v112, s47, v14
    v_fma_f32 v113, v113, s47, v14
    ds_read_b128 a[96:99], v34 offset:32768
    s_waitcnt lgkmcnt(3)
    v_mfma_f32_32x32x16_bf16 v[64:79], a[108:111], a[76:79], v[64:79]
    v_fma_f32 v114, v114, s47, v14
    v_fma_f32 v115, v115, s47, v14
    v_exp_f32 v112, v112
    v_exp_f32 v113, v113
    ds_read_b128 a[100:103], v35 offset:32768
    s_waitcnt lgkmcnt(3)
    v_mfma_f32_32x32x16_bf16 v[64:79], a[112:115], a[80:83], v[64:79]
    v_exp_f32 v114, v114
    v_exp_f32 v115, v115
    v_add_f32 v16, v16, v112
    v_add_f32 v17, v17, v113
    ds_read_b128 a[104:107], v28 offset:36864
    s_waitcnt lgkmcnt(3)
    v_mfma_f32_32x32x16_bf16 v[64:79], a[116:119], a[84:87], v[64:79]
    v_add_f32 v18, v18, v114
    v_add_f32 v19, v19, v115
    v_cvt_pk_bf16_f32 v112, v112, v113
    v_cvt_pk_bf16_f32 v113, v114, v115
    v_fma_f32 v116, v116, s47, v14
    ds_read_b128 a[108:111], v29 offset:36864
    s_waitcnt lgkmcnt(3)
    v_mfma_f32_32x32x16_bf16 v[64:79], a[96:99], a[88:91], v[64:79]
    v_fma_f32 v117, v117, s47, v14
    v_fma_f32 v118, v118, s47, v14
    v_fma_f32 v119, v119, s47, v14
    v_exp_f32 v116, v116
    ds_read_b128 a[112:115], v30 offset:36864
    s_waitcnt lgkmcnt(3)
    v_mfma_f32_32x32x16_bf16 v[64:79], a[100:103], a[92:95], v[64:79]
    v_exp_f32 v117, v117
    v_exp_f32 v118, v118
    v_exp_f32 v119, v119
    v_add_f32 v16, v16, v116
    ds_read_b128 a[116:119], v31 offset:36864
    s_waitcnt lgkmcnt(3)
    v_mfma_f32_32x32x16_bf16 v[80:95], a[104:107], a[64:67], 0
    v_add_f32 v17, v17, v117
    v_add_f32 v18, v18, v118
    v_add_f32 v19, v19, v119
    v_cvt_pk_bf16_f32 v114, v116, v117
    ds_read_b128 a[96:99], v32 offset:36864
    s_waitcnt lgkmcnt(3)
    v_mfma_f32_32x32x16_bf16 v[80:95], a[108:111], a[68:71], v[80:95]
    v_cvt_pk_bf16_f32 v115, v118, v119
    v_fma_f32 v120, v120, s47, v14
    v_fma_f32 v121, v121, s47, v14
    v_fma_f32 v122, v122, s47, v14
    ds_read_b128 a[100:103], v33 offset:36864
    s_waitcnt lgkmcnt(3)
    v_mfma_f32_32x32x16_bf16 v[80:95], a[112:115], a[72:75], v[80:95]
    v_fma_f32 v123, v123, s47, v14
    v_exp_f32 v120, v120
    v_exp_f32 v121, v121
    v_exp_f32 v122, v122
    v_exp_f32 v123, v123
    ds_read_b128 a[104:107], v34 offset:36864
    s_waitcnt lgkmcnt(3)
    v_mfma_f32_32x32x16_bf16 v[80:95], a[116:119], a[76:79], v[80:95]
    v_add_f32 v16, v16, v120
    v_add_f32 v17, v17, v121
    v_add_f32 v18, v18, v122
    v_add_f32 v19, v19, v123
    ds_read_b128 a[108:111], v35 offset:36864
    s_waitcnt lgkmcnt(3)
    v_mfma_f32_32x32x16_bf16 v[80:95], a[96:99], a[80:83], v[80:95]
    v_cvt_pk_bf16_f32 v120, v120, v121
    v_cvt_pk_bf16_f32 v121, v122, v123
    v_fma_f32 v124, v124, s47, v14
    v_fma_f32 v125, v125, s47, v14
    s_cmp_eq_u32 s59, 1
    s_cbranch_scc0 K1_R32
    s_waitcnt vmcnt(8)
K1_R32:
    s_barrier
    s_cmp_eq_u32 s59, 0
    s_cbranch_scc0 K1_R33
    s_add_u32 m0, s44, 65536
    s_add_u32 s46, s45, 98304
    buffer_load_dwordx4 v11, s[24:27], s46 offen nt lds
    s_add_u32 m0, s44, 69632
    s_add_u32 s46, s45, 102400
    buffer_load_dwordx4 v11, s[24:27], s46 offen nt lds
    s_add_u32 m0, s44, 73728
    s_add_u32 s46, s45, 106496
    buffer_load_dwordx4 v11, s[24:27], s46 offen nt lds
    s_add_u32 m0, s44, 77824
    s_add_u32 s46, s45, 110592
    buffer_load_dwordx4 v11, s[24:27], s46 offen nt lds
    s_add_u32 m0, s44, 81920
    s_add_u32 s46, s45, 114688
    buffer_load_dwordx4 v11, s[24:27], s46 offen nt lds
    s_add_u32 m0, s44, 86016
    s_add_u32 s46, s45, 118784
    buffer_load_dwordx4 v11, s[24:27], s46 offen nt lds
    s_add_u32 m0, s44, 90112
    s_add_u32 s46, s45, 122880
    buffer_load_dwordx4 v11, s[24:27], s46 offen nt lds
    s_add_u32 m0, s44, 94208
    s_add_u32 s46, s45, 126976
    buffer_load_dwordx4 v11, s[24:27], s46 offen nt lds
K1_R33:
    ds_read_b64_tr_b16 a[112:113], v44 offset:32768
    ds_read_b64_tr_b16 a[114:115], v44 offset:33792
    s_waitcnt lgkmcnt(4)
    v_mfma_f32_32x32x16_bf16 v[80:95], a[100:103], a[84:87], v[80:95]
    v_fma_f32 v126, v126, s47, v14
    v_fma_f32 v127, v127, s47, v14
    v_exp_f32 v124, v124
    v_exp_f32 v125, v125
    ds_read_b64_tr_b16 a[116:117], v45 offset:32768
    ds_read_b64_tr_b16 a[118:119], v45 offset:33792
    s_waitcnt lgkmcnt(5)
    v_mfma_f32_32x32x16_bf16 v[80:95], a[104:107], a[88:91], v[80:95]
    v_exp_f32 v126, v126
    v_exp_f32 v127, v127
    v_add_f32 v16, v16, v124
    v_add_f32 v17, v17, v125
    ds_read_b64_tr_b16 a[96:97], v46 offset:32768
    ds_read_b64_tr_b16 a[98:99], v46 offset:33792
    s_waitcnt lgkmcnt(6)
    v_mfma_f32_32x32x16_bf16 v[80:95], a[108:111], a[92:95], v[80:95]
    v_add_f32 v18, v18, v126
    v_add_f32 v19, v19, v127
    v_cvt_pk_bf16_f32 v122, v124, v125
    v_cvt_pk_bf16_f32 v123, v126, v127
    s_cmp_lg_u32 s49, 0
    s_cbranch_scc1 K1_RES1
K1_RESR1:
    ds_read_b64_tr_b16 a[100:101], v47 offset:32768
    ds_read_b64_tr_b16 a[102:103], v47 offset:33792
    s_waitcnt lgkmcnt(6)
    v_mfma_f32_32x32x16_bf16 a[0:15], a[112:115], v[96:99], a[0:15]
    ds_read_b64_tr_b16 a[104:105], v44 offset:34816
    ds_read_b64_tr_b16 a[106:107], v44 offset:35840
    s_waitcnt lgkmcnt(6)
    v_mfma_f32_32x32x16_bf16 a[16:31], a[116:119], v[96:99], a[16:31]
    v_max3_f32 v2, v64, v65, v66
    v_max3_f32 v2, v2, v67, v68
    v_max3_f32 v2, v2, v69, v70
    v_max3_f32 v2, v2, v71, v72
    v_max3_f32 v2, v2, v73, v74
    ds_read_b64_tr_b16 a[108:109], v45 offset:34816
    ds_read_b64_tr_b16 a[110:111], v45 offset:35840
    s_waitcnt lgkmcnt(6)
    v_mfma_f32_32x32x16_bf16 a[32:47], a[96:99], v[96:99], a[32:47]
    v_max3_f32 v2, v2, v75, v76
    v_max3_f32 v2, v2, v77, v78
    v_max_f32 v2, v2, v79
    v_max3_f32 v3, v80, v81, v82
    ds_read_b64_tr_b16 a[112:113], v46 offset:34816
    ds_read_b64_tr_b16 a[114:115], v46 offset:35840
    s_waitcnt lgkmcnt(6)
    v_mfma_f32_32x32x16_bf16 a[48:63], a[100:103], v[96:99], a[48:63]
    v_max3_f32 v3, v3, v83, v84
    v_max3_f32 v3, v3, v85, v86
    v_max3_f32 v3, v3, v87, v88
    v_max3_f32 v3, v3, v89, v90
    ds_read_b64_tr_b16 a[116:117], v47 offset:34816
    ds_read_b64_tr_b16 a[118:119], v47 offset:35840
    s_waitcnt lgkmcnt(6)
    v_mfma_f32_32x32x16_bf16 a[0:15], a[104:107], v[104:107], a[0:15]
    v_max3_f32 v3, v3, v91, v92
    v_max3_f32 v3, v3, v93, v94
    v_max_f32 v3, v3, v95
    v_max_f32 v2, v2, v3
    ds_read_b64_tr_b16 a[96:97], v44 offset:36864
    ds_read_b64_tr_b16 a[98:99], v44 offset:37888
    s_waitcnt lgkmcnt(6)
    v_mfma_f32_32x32x16_bf16 a[16:31], a[108:111], v[104:107], a[16:31]
    v_mov_b32 v3, v2
    s_nop 1
    v_permlane32_swap_b32 v3, v2
    v_max_f32 v2, v2, v3
    v_sub_f32 v3, v2, v13
    v_cmp_lt_f32 vcc, s48, v3
    s_cbranch_vccnz K1_UPD2
K1_UPDR2:
    v_fma_f32 v64, v64, s47, v14
    v_fma_f32 v65, v65, s47, v14
    v_fma_f32 v66, v66, s47, v14
    ds_read_b64_tr_b16 a[100:101], v45 offset:36864
    ds_read_b64_tr_b16 a[102:103], v45 offset:37888
    s_waitcnt lgkmcnt(6)
    v_mfma_f32_32x32x16_bf16 a[32:47], a[112:115], v[104:107], a[32:47]
    v_fma_f32 v67, v67, s47, v14
    v_exp_f32 v64, v64
    v_exp_f32 v65, v65
    v_exp_f32 v66, v66
    v_exp_f32 v67, v67
    ds_read_b64_tr_b16 a[104:105], v46 offset:36864
    ds_read_b64_tr_b16 a[106:107], v46 offset:37888
    s_waitcnt lgkmcnt(6)
    v_mfma_f32_32x32x16_bf16 a[48:63], a[116:119], v[104:107], a[48:63]
    v_add_f32 v16, v16, v64
    v_add_f32 v17, v17, v65
    v_add_f32 v18, v18, v66
    v_add_f32 v19, v19, v67
    ds_read_b64_tr_b16 a[108:109], v47 offset:36864
    ds_read_b64_tr_b16 a[110:111], v47 offset:37888
    s_waitcnt lgkmcnt(6)
    v_mfma_f32_32x32x16_bf16 a[0:15], a[96:99], v[112:115], a[0:15]
    v_cvt_pk_bf16_f32 v64, v64, v65
    v_cvt_pk_bf16_f32 v65, v66, v67
    v_fma_f32 v68, v68, s47, v14
    v_fma_f32 v69, v69, s47, v14
    ds_read_b64_tr_b16 a[112:113], v44 offset:38912
    ds_read_b64_tr_b16 a[114:115], v44 offset:39936
    s_waitcnt lgkmcnt(6)
    v_mfma_f32_32x32x16_bf16 a[16:31], a[100:103], v[112:115], a[16:31]
    v_fma_f32 v70, v70, s47, v14
    v_fma_f32 v71, v71, s47, v14
    v_exp_f32 v68, v68
    v_exp_f32 v69, v69
    ds_read_b64_tr_b16 a[116:117], v45 offset:38912
    ds_read_b64_tr_b16 a[118:119], v45 offset:39936
    s_waitcnt lgkmcnt(6)
    v_mfma_f32_32x32x16_bf16 a[32:47], a[104:107], v[112:115], a[32:47]
    v_exp_f32 v70, v70
    v_exp_f32 v71, v71
    v_add_f32 v16, v16, v68
    v_add_f32 v17, v17, v69
    ds_read_b64_tr_b16 a[96:97], v46 offset:38912
    ds_read_b64_tr_b16 a[98:99], v46 offset:39936
    s_waitcnt lgkmcnt(6)
    v_mfma_f32_32x32x16_bf16 a[48:63], a[108:111], v[112:115], a[48:63]
    v_add_f32 v18, v18, v70
    v_add_f32 v19, v19, v71
    v_cvt_pk_bf16_f32 v66, v68, v69
    v_cvt_pk_bf16_f32 v67, v70, v71
    v_fma_f32 v72, v72, s47, v14
    ds_read_b64_tr_b16 a[100:101], v47 offset:38912
    ds_read_b64_tr_b16 a[102:103], v47 offset:39936
    s_waitcnt lgkmcnt(6)
    v_mfma_f32_32x32x16_bf16 a[0:15], a[112:115], v[120:123], a[0:15]
    v_fma_f32 v73, v73, s47, v14
    v_fma_f32 v74, v74, s47, v14
    v_fma_f32 v75, v75, s47, v14
    v_exp_f32 v72, v72
    s_cmp_eq_u32 s59, 0
    s_cbranch_scc0 K1_R34
    s_waitcnt vmcnt(8)
K1_R34:
    s_barrier
    ds_read_b128 a[104:107], v36 offset:0
    s_waitcnt lgkmcnt(5)
    v_mfma_f32_32x32x16_bf16 a[16:31], a[116:119], v[120:123], a[16:31]
    v_exp_f32 v73, v73
    v_exp_f32 v74, v74
    v_exp_f32 v75, v75
    v_add_f32 v16, v16, v72
    ds_read_b128 a[108:111], v37 offset:0
    s_waitcnt lgkmcnt(4)
    v_mfma_f32_32x32x16_bf16 a[32:47], a[96:99], v[120:123], a[32:47]
    v_add_f32 v17, v17, v73
    v_add_f32 v18, v18, v74
    v_add_f32 v19, v19, v75
    v_cvt_pk_bf16_f32 v72, v72, v73
    ds_read_b128 a[112:115], v38 offset:0
    s_waitcnt lgkmcnt(3)
    v_mfma_f32_32x32x16_bf16 a[48:63], a[100:103], v[120:123], a[48:63]
    v_cvt_pk_bf16_f32 v73, v74, v75
    v_fma_f32 v76, v76, s47, v14
    v_fma_f32 v77, v77, s47, v14
    v_fma_f32 v78, v78, s47, v14
    ds_read_b128 a[116:119], v39 offset:0
    s_waitcnt lgkmcnt(3)
    v_mfma_f32_32x32x16_bf16 v[96:111], a[104:107], a[64:67], 0
    v_fma_f32 v79, v79, s47, v14
    v_exp_f32 v76, v76
    v_exp_f32 v77, v77
    v_exp_f32 v78, v78
    v_exp_f32 v79, v79
    ds_read_b128 a[96:99], v40 offset:0
    s_waitcnt lgkmcnt(3)
    v_mfma_f32_32x32x16_bf16 v[96:111], a[108:111], a[68:71], v[96:111]
    v_add_f32 v16, v16, v76
    v_add_f32 v17, v17, v77
    v_add_f32 v18, v18, v78
    v_add_f32 v19, v19, v79
    ds_read_b128 a[100:103], v41 offset:0
    s_waitcnt lgkmcnt(3)
    v_mfma_f32_32x32x16_bf16 v[96:111], a[112:115], a[72:75], v[96:111]
    v_cvt_pk_bf16_f32 v74, v76, v77
    v_cvt_pk_bf16_f32 v75, v78, v79
    v_fma_f32 v80, v80, s47, v14
    v_fma_f32 v81, v81, s47, v14
    ds_read_b128 a[104:107], v42 offset:0
    s_waitcnt lgkmcnt(3)
    v_mfma_f32_32x32x16_bf16 v[96:111], a[116:119], a[76:79], v[96:111]
    v_fma_f32 v82, v82, s47, v14
    v_fma_f32 v83, v83, s47, v14
    v_exp_f32 v80, v80
    v_exp_f32 v81, v81
    ds_read_b128 a[108:111], v43 offset:0
    s_waitcnt lgkmcnt(3)
    v_mfma_f32_32x32x16_bf16 v[96:111], a[96:99], a[80:83], v[96:111]
    v_exp_f32 v82, v82
    v_exp_f32 v83, v83
    v_add_f32 v16, v16, v80
    v_add_f32 v17, v17, v81
    ds_read_b128 a[112:115], v36 offset:4096
    s_waitcnt lgkmcnt(3)
    v_mfma_f32_32x32x16_bf16 v[96:111], a[100:103], a[84:87], v[96:111]
    v_add_f32 v18, v18, v82
    v_add_f32 v19, v19, v83
    v_cvt_pk_bf16_f32 v80, v80, v81
    v_cvt_pk_bf16_f32 v81, v82, v83
    v_fma_f32 v84, v84, s47, v14
    ds_read_b128 a[116:119], v37 offset:4096
    s_waitcnt lgkmcnt(3)
    v_mfma_f32_32x32x16_bf16 v[96:111], a[104:107], a[88:91], v[96:111]
    v_fma_f32 v85, v85, s47, v14
    v_fma_f32 v86, v86, s47, v14
    v_fma_f32 v87, v87, s47, v14
    v_exp_f32 v84, v84
    ds_read_b128 a[96:99], v38 offset:4096
    s_waitcnt lgkmcnt(3)
    v_mfma_f32_32x32x16_bf16 v[96:111], a[108:111], a[92:95], v[96:111]
    v_exp_f32 v85, v85
    v_exp_f32 v86, v86
    v_exp_f32 v87, v87
    v_add_f32 v16, v16, v84
    ds_read_b128 a[100:103], v39 offset:4096
    s_waitcnt lgkmcnt(3)
    v_mfma_f32_32x32x16_bf16 v[112:127], a[112:115], a[64:67], 0
    v_add_f32 v17, v17, v85
    v_add_f32 v18, v18, v86
    v_add_f32 v19, v19, v87
    v_cvt_pk_bf16_f32 v82, v84, v85
    ds_read_b128 a[104:107], v40 offset:4096
    s_waitcnt lgkmcnt(3)
    v_mfma_f32_32x32x16_bf16 v[112:127], a[116:119], a[68:71], v[112:127]
    v_cvt_pk_bf16_f32 v83, v86, v87
    v_fma_f32 v88, v88, s47, v14
    v_fma_f32 v89, v89, s47, v14
    v_fma_f32 v90, v90, s47, v14
    ds_read_b128 a[108:111], v41 offset:4096
    s_waitcnt lgkmcnt(3)
    v_mfma_f32_32x32x16_bf16 v[112:127], a[96:99], a[72:75], v[112:127]
    v_fma_f32 v91, v91, s47, v14
    v_exp_f32 v88, v88
    v_exp_f32 v89, v89
    v_exp_f32 v90, v90
    v_exp_f32 v91, v91
    ds_read_b128 a[112:115], v42 offset:4096
    s_waitcnt lgkmcnt(3)
    v_mfma_f32_32x32x16_bf16 v[112:127], a[100:103], a[76:79], v[112:127]
    v_add_f32 v16, v16, v88
    v_add_f32 v17, v17, v89
    v_add_f32 v18, v18, v90
    v_add_f32 v19, v19, v91
    ds_read_b128 a[116:119], v43 offset:4096
    s_waitcnt lgkmcnt(3)
    v_mfma_f32_32x32x16_bf16 v[112:127], a[104:107], a[80:83], v[112:127]
    v_cvt_pk_bf16_f32 v88, v88, v89
    v_cvt_pk_bf16_f32 v89, v90, v91
    v_fma_f32 v92, v92, s47, v14
    v_fma_f32 v93, v93, s47, v14
    s_cmp_eq_u32 s59, 1
    s_cbranch_scc0 K1_R35
    s_waitcnt vmcnt(0)
K1_R35:
    s_barrier
    ds_read_b64_tr_b16 a[96:97], v44 offset:0
    ds_read_b64_tr_b16 a[98:99], v44 offset:1024
    s_waitcnt lgkmcnt(4)
    v_mfma_f32_32x32x16_bf16 v[112:127], a[108:111], a[84:87], v[112:127]
    v_fma_f32 v94, v94, s47, v14
    v_fma_f32 v95, v95, s47, v14
    v_exp_f32 v92, v92
    v_exp_f32 v93, v93
    ds_read_b64_tr_b16 a[100:101], v45 offset:0
    ds_read_b64_tr_b16 a[102:103], v45 offset:1024
    s_waitcnt lgkmcnt(5)
    v_mfma_f32_32x32x16_bf16 v[112:127], a[112:115], a[88:91], v[112:127]
    v_exp_f32 v94, v94
    v_exp_f32 v95, v95
    v_add_f32 v16, v16, v92
    v_add_f32 v17, v17, v93
    ds_read_b64_tr_b16 a[104:105], v46 offset:0
    ds_read_b64_tr_b16 a[106:107], v46 offset:1024
    s_waitcnt lgkmcnt(6)
    v_mfma_f32_32x32x16_bf16 v[112:127], a[116:119], a[92:95], v[112:127]
    v_add_f32 v18, v18, v94
    v_add_f32 v19, v19, v95
    v_cvt_pk_bf16_f32 v90, v92, v93
    v_cvt_pk_bf16_f32 v91, v94, v95
    s_cmp_lg_u32 s49, 0
    s_cbranch_scc1 K1_RES2
K1_RESR2:
    ds_read_b64_tr_b16 a[108:109], v47 offset:0
    ds_read_b64_tr_b16 a[110:111], v47 offset:1024
    s_waitcnt lgkmcnt(6)
    v_mfma_f32_32x32x16_bf16 a[0:15], a[96:99], v[64:67], a[0:15]
    ds_read_b64_tr_b16 a[112:113], v44 offset:2048
    ds_read_b64_tr_b16 a[114:115], v44 offset:3072
    s_waitcnt lgkmcnt(6)
    v_mfma_f32_32x32x16_bf16 a[16:31], a[100:103], v[64:67], a[16:31]
    v_max3_f32 v2, v96, v97, v98
    v_max3_f32 v2, v2, v99, v100
    v_max3_f32 v2, v2, v101, v102
    v_max3_f32 v2, v2, v103, v104
    v_max3_f32 v2, v2, v105, v106
    v_max3_f32 v2, v2, v107, v108
    v_max3_f32 v2, v2, v109, v110
    v_max_f32 v2, v2, v111
    v_max3_f32 v3, v112, v113, v114
    ds_read_b64_tr_b16 a[116:117], v45 offset:2048
    ds_read_b64_tr_b16 a[118:119], v45 offset:3072
    s_waitcnt lgkmcnt(6)
    v_mfma_f32_32x32x16_bf16 a[32:47], a[104:107], v[64:67], a[32:47]
    v_max3_f32 v3, v3, v115, v116
    v_max3_f32 v3, v3, v117, v118
    v_max3_f32 v3, v3, v119, v120
    v_max3_f32 v3, v3, v121, v122
    v_max3_f32 v3, v3, v123, v124
    v_max3_f32 v3, v3, v125, v126
    v_max_f32 v3, v3, v127
    v_max_f32 v2, v2, v3
    v_mov_b32 v3, v2
    s_nop 1
    v_permlane32_swap_b32 v3, v2
    v_max_f32 v2, v2, v3
    v_sub_f32 v3, v2, v13
    v_cmp_lt_f32 vcc, s48, v3
    s_cbranch_vccnz K1_UPD3
K1_UPDR3:
    ds_read_b64_tr_b16 a[96:97], v46 offset:2048
    ds_read_b64_tr_b16 a[98:99], v46 offset:3072
    s_waitcnt lgkmcnt(6)
    v_mfma_f32_32x32x16_bf16 a[48:63], a[108:111], v[64:67], a[48:63]
    v_fma_f32 v96, v96, s47, v14
    v_fma_f32 v97, v97, s47, v14
    v_fma_f32 v98, v98, s47, v14
    v_fma_f32 v99, v99, s47, v14
    v_exp_f32 v96, v96
    v_exp_f32 v97, v97
    v_exp_f32 v98, v98
    v_exp_f32 v99, v99
    ds_read_b64_tr_b16 a[100:101], v47 offset:2048
    ds_read_b64_tr_b16 a[102:103], v47 offset:3072
    s_waitcnt lgkmcnt(6)
    v_mfma_f32_32x32x16_bf16 a[0:15], a[112:115], v[72:75], a[0:15]
    v_add_f32 v16, v16, v96
    v_add_f32 v17, v17, v97
    v_add_f32 v18, v18, v98
    v_add_f32 v19, v19, v99
    v_cvt_pk_bf16_f32 v96, v96, v97
    v_cvt_pk_bf16_f32 v97, v98, v99
    v_fma_f32 v100, v100, s47, v14
    v_fma_f32 v101, v101, s47, v14
    v_fma_f32 v102, v102, s47, v14
    ds_read_b64_tr_b16 a[104:105], v44 offset:4096
    ds_read_b64_tr_b16 a[106:107], v44 offset:5120
    s_waitcnt lgkmcnt(6)
    v_mfma_f32_32x32x16_bf16 a[16:31], a[116:119], v[72:75], a[16:31]
    v_fma_f32 v103, v103, s47, v14
    v_exp_f32 v100, v100
    v_exp_f32 v101, v101
    v_exp_f32 v102, v102
    v_exp_f32 v103, v103
    v_add_f32 v16, v16, v100
    v_add_f32 v17, v17, v101
    v_add_f32 v18, v18, v102
    v_add_f32 v19, v19, v103
    ds_read_b64_tr_b16 a[108:109], v45 offset:4096
    ds_read_b64_tr_b16 a[110:111], v45 offset:5120
    s_waitcnt lgkmcnt(6)
    v_mfma_f32_32x32x16_bf16 a[32:47], a[96:99], v[72:75], a[32:47]
    v_cvt_pk_bf16_f32 v98, v100, v101
    v_cvt_pk_bf16_f32 v99, v102, v103
    v_fma_f32 v104, v104, s47, v14
    v_fma_f32 v105, v105, s47, v14
    v_fma_f32 v106, v106, s47, v14
    v_fma_f32 v107, v107, s47, v14
    v_exp_f32 v104, v104
    v_exp_f32 v105, v105
    ds_read_b64_tr_b16 a[112:113], v46 offset:4096
    ds_read_b64_tr_b16 a[114:115], v46 offset:5120
    s_waitcnt lgkmcnt(6)
    v_mfma_f32_32x32x16_bf16 a[48:63], a[100:103], v[72:75], a[48:63]
    v_exp_f32 v106, v106
    v_exp_f32 v107, v107
    v_add_f32 v16, v16, v104
    v_add_f32 v17, v17, v105
    v_add_f32 v18, v18, v106
    v_add_f32 v19, v19, v107
    v_cvt_pk_bf16_f32 v104, v104, v105
    v_cvt_pk_bf16_f32 v105, v106, v107
    v_fma_f32 v108, v108, s47, v14
    ds_read_b64_tr_b16 a[116:117], v47 offset:4096
    ds_read_b64_tr_b16 a[118:119], v47 offset:5120
    s_waitcnt lgkmcnt(6)
    v_mfma_f32_32x32x16_bf16 a[0:15], a[104:107], v[80:83], a[0:15]
    v_fma_f32 v109, v109, s47, v14
    v_fma_f32 v110, v110, s47, v14
    v_fma_f32 v111, v111, s47, v14
    v_exp_f32 v108, v108
    v_exp_f32 v109, v109
    v_exp_f32 v110, v110
    v_exp_f32 v111, v111
    v_add_f32 v16, v16, v108
    v_add_f32 v17, v17, v109
    ds_read_b64_tr_b16 a[96:97], v44 offset:6144
    ds_read_b64_tr_b16 a[98:99], v44 offset:7168
    s_waitcnt lgkmcnt(6)
    v_mfma_f32_32x32x16_bf16 a[16:31], a[108:111], v[80:83], a[16:31]
    v_add_f32 v18, v18, v110
    v_add_f32 v19, v19, v111
    v_cvt_pk_bf16_f32 v106, v108, v109
    v_cvt_pk_bf16_f32 v107, v110, v111
    v_fma_f32 v112, v112, s47, v14
    v_fma_f32 v113, v113, s47, v14
    v_fma_f32 v114, v114, s47, v14
    v_fma_f32 v115, v115, s47, v14
    ds_read_b64_tr_b16 a[100:101], v45 offset:6144
    ds_read_b64_tr_b16 a[102:103], v45 offset:7168
    s_waitcnt lgkmcnt(6)
    v_mfma_f32_32x32x16_bf16 a[32:47], a[112:115], v[80:83], a[32:47]
    v_exp_f32 v112, v112
    v_exp_f32 v113, v113
    v_exp_f32 v114, v114
    v_exp_f32 v115, v115
    v_add_f32 v16, v16, v112
    v_add_f32 v17, v17, v113
    v_add_f32 v18, v18, v114
    v_add_f32 v19, v19, v115
    v_cvt_pk_bf16_f32 v112, v112, v113
    ds_read_b64_tr_b16 a[104:105], v46 offset:6144
    ds_read_b64_tr_b16 a[106:107], v46 offset:7168
    s_waitcnt lgkmcnt(6)
    v_mfma_f32_32x32x16_bf16 a[48:63], a[116:119], v[80:83], a[48:63]
    v_cvt_pk_bf16_f32 v113, v114, v115
    v_fma_f32 v116, v116, s47, v14
    v_fma_f32 v117, v117, s47, v14
    v_fma_f32 v118, v118, s47, v14
    v_fma_f32 v119, v119, s47, v14
    v_exp_f32 v116, v116
    v_exp_f32 v117, v117
    v_exp_f32 v118, v118
    v_exp_f32 v119, v119
    ds_read_b64_tr_b16 a[108:109], v47 offset:6144
    ds_read_b64_tr_b16 a[110:111], v47 offset:7168
    s_waitcnt lgkmcnt(6)
    v_mfma_f32_32x32x16_bf16 a[0:15], a[96:99], v[88:91], a[0:15]
    v_add_f32 v16, v16, v116
    v_add_f32 v17, v17, v117
    v_add_f32 v18, v18, v118
    v_add_f32 v19, v19, v119
    v_cvt_pk_bf16_f32 v114, v116, v117
    v_cvt_pk_bf16_f32 v115, v118, v119
    v_fma_f32 v120, v120, s47, v14
    v_fma_f32 v121, v121, s47, v14
    s_cmp_eq_u32 s59, 0
    s_cbranch_scc0 K1_R36
    s_waitcnt vmcnt(0)
K1_R36:
    s_barrier
    ds_read_b64_tr_b16 a[112:113], v48 offset:0
    ds_read_b64_tr_b16 a[114:115], v48 offset:1024
    s_waitcnt lgkmcnt(6)
    v_mfma_f32_32x32x16_bf16 a[16:31], a[100:103], v[88:91], a[16:31]
    v_fma_f32 v122, v122, s47, v14
    v_fma_f32 v123, v123, s47, v14
    v_exp_f32 v120, v120
    v_exp_f32 v121, v121
    v_exp_f32 v122, v122
    v_exp_f32 v123, v123
    v_add_f32 v16, v16, v120
    v_add_f32 v17, v17, v121
    v_add_f32 v18, v18, v122
    ds_read_b64_tr_b16 a[116:117], v49 offset:0
    ds_read_b64_tr_b16 a[118:119], v49 offset:1024
    s_waitcnt lgkmcnt(6)
    v_mfma_f32_32x32x16_bf16 a[32:47], a[104:107], v[88:91], a[32:47]
    v_add_f32 v19, v19, v123
    v_cvt_pk_bf16_f32 v120, v120, v121
    v_cvt_pk_bf16_f32 v121, v122, v123
    v_fma_f32 v124, v124, s47, v14
    v_fma_f32 v125, v125, s47, v14
    v_fma_f32 v126, v126, s47, v14
    v_fma_f32 v127, v127, s47, v14
    v_exp_f32 v124, v124
    v_exp_f32 v125, v125
    ds_read_b64_tr_b16 a[96:97], v50 offset:0
    ds_read_b64_tr_b16 a[98:99], v50 offset:1024
    s_waitcnt lgkmcnt(6)
    v_mfma_f32_32x32x16_bf16 a[48:63], a[108:111], v[88:91], a[48:63]
    v_exp_f32 v126, v126
    v_exp_f32 v127, v127
    v_add_f32 v16, v16, v124
    v_add_f32 v17, v17, v125
    v_add_f32 v18, v18, v126
    v_add_f32 v19, v19, v127
    v_cvt_pk_bf16_f32 v122, v124, v125
    v_cvt_pk_bf16_f32 v123, v126, v127
    s_cmp_lg_u32 s49, 0
    s_cbranch_scc1 K1_RES3
K1_RESR3:
    ds_read_b64_tr_b16 a[100:101], v51 offset:0
    ds_read_b64_tr_b16 a[102:103], v51 offset:1024
    s_waitcnt lgkmcnt(6)
    v_mfma_f32_32x32x16_bf16 a[0:15], a[112:115], v[96:99], a[0:15]
    ds_read_b64_tr_b16 a[104:105], v48 offset:2048
    ds_read_b64_tr_b16 a[106:107], v48 offset:3072
    s_waitcnt lgkmcnt(6)
    v_mfma_f32_32x32x16_bf16 a[16:31], a[116:119], v[96:99], a[16:31]
    ds_read_b64_tr_b16 a[108:109], v49 offset:2048
    ds_read_b64_tr_b16 a[110:111], v49 offset:3072
    s_waitcnt lgkmcnt(6)
    v_mfma_f32_32x32x16_bf16 a[32:47], a[96:99], v[96:99], a[32:47]
    ds_read_b64_tr_b16 a[112:113], v50 offset:2048
    ds_read_b64_tr_b16 a[114:115], v50 offset:3072
    s_waitcnt lgkmcnt(6)
    v_mfma_f32_32x32x16_bf16 a[48:63], a[100:103], v[96:99], a[48:63]
    ds_read_b64_tr_b16 a[116:117], v51 offset:2048
    ds_read_b64_tr_b16 a[118:119], v51 offset:3072
    s_waitcnt lgkmcnt(6)
    v_mfma_f32_32x32x16_bf16 a[0:15], a[104:107], v[104:107], a[0:15]
    ds_read_b64_tr_b16 a[96:97], v48 offset:4096
    ds_read_b64_tr_b16 a[98:99], v48 offset:5120
    s_waitcnt lgkmcnt(6)
    v_mfma_f32_32x32x16_bf16 a[16:31], a[108:111], v[104:107], a[16:31]
    ds_read_b64_tr_b16 a[100:101], v49 offset:4096
    ds_read_b64_tr_b16 a[102:103], v49 offset:5120
    s_waitcnt lgkmcnt(6)
    v_mfma_f32_32x32x16_bf16 a[32:47], a[112:115], v[104:107], a[32:47]
    ds_read_b64_tr_b16 a[104:105], v50 offset:4096
    ds_read_b64_tr_b16 a[106:107], v50 offset:5120
    s_waitcnt lgkmcnt(6)
    v_mfma_f32_32x32x16_bf16 a[48:63], a[116:119], v[104:107], a[48:63]
    ds_read_b64_tr_b16 a[108:109], v51 offset:4096
    ds_read_b64_tr_b16 a[110:111], v51 offset:5120
    s_waitcnt lgkmcnt(6)
    v_mfma_f32_32x32x16_bf16 a[0:15], a[96:99], v[112:115], a[0:15]
    ds_read_b64_tr_b16 a[112:113], v48 offset:6144
    ds_read_b64_tr_b16 a[114:115], v48 offset:7168
    s_waitcnt lgkmcnt(6)
    v_mfma_f32_32x32x16_bf16 a[16:31], a[100:103], v[112:115], a[16:31]
    ds_read_b64_tr_b16 a[116:117], v49 offset:6144
    ds_read_b64_tr_b16 a[118:119], v49 offset:7168
    s_waitcnt lgkmcnt(6)
    v_mfma_f32_32x32x16_bf16 a[32:47], a[104:107], v[112:115], a[32:47]
    ds_read_b64_tr_b16 a[96:97], v50 offset:6144
    ds_read_b64_tr_b16 a[98:99], v50 offset:7168
    s_waitcnt lgkmcnt(6)
    v_mfma_f32_32x32x16_bf16 a[48:63], a[108:111], v[112:115], a[48:63]
    ds_read_b64_tr_b16 a[100:101], v51 offset:6144
    ds_read_b64_tr_b16 a[102:103], v51 offset:7168
    s_waitcnt lgkmcnt(6)
    v_mfma_f32_32x32x16_bf16 a[0:15], a[112:115], v[120:123], a[0:15]
    s_waitcnt lgkmcnt(4)
    v_mfma_f32_32x32x16_bf16 a[16:31], a[116:119], v[120:123], a[16:31]
    s_waitcnt lgkmcnt(2)
    v_mfma_f32_32x32x16_bf16 a[32:47], a[96:99], v[120:123], a[32:47]
    s_waitcnt lgkmcnt(0)
    v_mfma_f32_32x32x16_bf16 a[48:63], a[100:103], v[120:123], a[48:63]
    s_mul_i32 s46, s2, 18432
    v_lshlrev_b32 v62, 4, v0
    buffer_load_dwordx4 v[56:59], v62, s[32:35], s46 offen
    s_add_u32 s46, s46, 8192
    buffer_load_dwordx4 v[56:59], v62, s[32:35], s46 offen
    s_add_u32 s46, s46, 8192
    buffer_load_dwordx4 v[56:59], v62, s[32:35], s46 offen
    v_add_f32 v16, v16, v17
    v_add_f32 v18, v18, v19
    v_add_f32 v2, v16, v18
    v_mov_b32 v3, v2
    s_nop 1
    v_permlane32_swap_b32 v3, v2
    v_add_f32 v16, v2, v3
    v_lshlrev_b32 v2, 4, v1
    s_lshl_b32 s54, s43, 13
    s_add_u32 s54, s54, 98304
    v_add_u32 v3, s54, v2
    s_nop 3
    ds_write_b128 v3, a[32:35] offset:0
    ds_write_b128 v3, a[36:39] offset:1024
    ds_write_b128 v3, a[40:43] offset:2048
    ds_write_b128 v3, a[44:47] offset:3072
    ds_write_b128 v3, a[48:51] offset:4096
    ds_write_b128 v3, a[52:55] offset:5120
    ds_write_b128 v3, a[56:59] offset:6144
    ds_write_b128 v3, a[60:63] offset:7168
    v_lshlrev_b32 v4, 3, v1
    s_lshl_b32 s54, s43, 9
    s_add_u32 s54, s54, 32768
    v_add_u32 v5, s54, v4
    v_mov_b32 v6, v13
    v_mov_b32 v7, v16
    ds_write_b64 v5, v[6:7]
    v_accvgpr_read_b32 v64, a0
    v_accvgpr_read_b32 v65, a1
    v_accvgpr_read_b32 v66, a2
    v_accvgpr_read_b32 v67, a3
    v_accvgpr_read_b32 v68, a4
    v_accvgpr_read_b32 v69, a5
    v_accvgpr_read_b32 v70, a6
    v_accvgpr_read_b32 v71, a7
    v_accvgpr_read_b32 v72, a8
    v_accvgpr_read_b32 v73, a9
    v_accvgpr_read_b32 v74, a10
    v_accvgpr_read_b32 v75, a11
    v_accvgpr_read_b32 v76, a12
    v_accvgpr_read_b32 v77, a13
    v_accvgpr_read_b32 v78, a14
    v_accvgpr_read_b32 v79, a15
    v_accvgpr_read_b32 v80, a16
    v_accvgpr_read_b32 v81, a17
    v_accvgpr_read_b32 v82, a18
    v_accvgpr_read_b32 v83, a19
    v_accvgpr_read_b32 v84, a20
    v_accvgpr_read_b32 v85, a21
    v_accvgpr_read_b32 v86, a22
    v_accvgpr_read_b32 v87, a23
    v_accvgpr_read_b32 v88, a24
    v_accvgpr_read_b32 v89, a25
    v_accvgpr_read_b32 v90, a26
    v_accvgpr_read_b32 v91, a27
    v_accvgpr_read_b32 v92, a28
    v_accvgpr_read_b32 v93, a29
    v_accvgpr_read_b32 v94, a30
    v_accvgpr_read_b32 v95, a31
    s_waitcnt lgkmcnt(0)
    s_barrier
    s_xor_b32 s57, s43, 4
    s_lshl_b32 s54, s57, 13
    s_add_u32 s54, s54, 98304
    v_add_u32 v3, s54, v2
    s_lshl_b32 s54, s57, 9
    s_add_u32 s54, s54, 32768
    v_add_u32 v5, s54, v4
    ds_read_b64 v[6:7], v5
    ds_read_b128 v[96:99], v3 offset:0
    ds_read_b128 v[100:103], v3 offset:1024
    ds_read_b128 v[104:107], v3 offset:2048
    ds_read_b128 v[108:111], v3 offset:3072
    ds_read_b128 v[112:115], v3 offset:4096
    ds_read_b128 v[116:119], v3 offset:5120
    ds_read_b128 v[120:123], v3 offset:6144
    ds_read_b128 v[124:127], v3 offset:7168
    s_waitcnt lgkmcnt(8)
    v_max_f32 v2, v13, v6
    v_sub_f32 v3, v13, v2
    v_sub_f32 v4, v6, v2
    v_mul_f32 v3, s47, v3
    v_mul_f32 v4, s47, v4
    v_exp_f32 v3, v3
    v_exp_f32 v4, v4
    s_nop 0
    v_mul_f32 v5, v16, v3
    v_fmac_f32 v5, v7, v4
    v_rcp_f32 v5, v5
    s_nop 0
    v_mul_f32 v3, v3, v5
    v_mul_f32 v4, v4, v5
    v_and_b32 v5, 31, v1
    s_lshl_b32 s54, s58, 5
    v_add_u32 v5, s54, v5
    v_cmp_gt_u32 vcc, 112, v5
    v_mul_f32 v64, v64, v3
    v_mul_f32 v65, v65, v3
    v_mul_f32 v66, v66, v3
    v_mul_f32 v67, v67, v3
    v_mul_f32 v68, v68, v3
    v_mul_f32 v69, v69, v3
    v_mul_f32 v70, v70, v3
    v_mul_f32 v71, v71, v3
    v_mul_f32 v72, v72, v3
    v_mul_f32 v73, v73, v3
    v_mul_f32 v74, v74, v3
    v_mul_f32 v75, v75, v3
    v_mul_f32 v76, v76, v3
    v_mul_f32 v77, v77, v3
    v_mul_f32 v78, v78, v3
    v_mul_f32 v79, v79, v3
    v_mul_f32 v80, v80, v3
    v_mul_f32 v81, v81, v3
    v_mul_f32 v82, v82, v3
    v_mul_f32 v83, v83, v3
    v_mul_f32 v84, v84, v3
    v_mul_f32 v85, v85, v3
    v_mul_f32 v86, v86, v3
    v_mul_f32 v87, v87, v3
    v_mul_f32 v88, v88, v3
    v_mul_f32 v89, v89, v3
    v_mul_f32 v90, v90, v3
    v_mul_f32 v91, v91, v3
    v_mul_f32 v92, v92, v3
    v_mul_f32 v93, v93, v3
    v_mul_f32 v94, v94, v3
    v_mul_f32 v95, v95, v3
    s_waitcnt lgkmcnt(0)
    v_fmac_f32 v64, v96, v4
    v_fmac_f32 v65, v97, v4
    v_fmac_f32 v66, v98, v4
    v_fmac_f32 v67, v99, v4
    v_fmac_f32 v68, v100, v4
    v_fmac_f32 v69, v101, v4
    v_fmac_f32 v70, v102, v4
    v_fmac_f32 v71, v103, v4
    v_fmac_f32 v72, v104, v4
    v_fmac_f32 v73, v105, v4
    v_fmac_f32 v74, v106, v4
    v_fmac_f32 v75, v107, v4
    v_fmac_f32 v76, v108, v4
    v_fmac_f32 v77, v109, v4
    v_fmac_f32 v78, v110, v4
    v_fmac_f32 v79, v111, v4
    v_fmac_f32 v80, v112, v4
    v_fmac_f32 v81, v113, v4
    v_fmac_f32 v82, v114, v4
    v_fmac_f32 v83, v115, v4
    v_fmac_f32 v84, v116, v4
    v_fmac_f32 v85, v117, v4
    v_fmac_f32 v86, v118, v4
    v_fmac_f32 v87, v119, v4
    v_fmac_f32 v88, v120, v4
    v_fmac_f32 v89, v121, v4
    v_fmac_f32 v90, v122, v4
    v_fmac_f32 v91, v123, v4
    v_fmac_f32 v92, v124, v4
    v_fmac_f32 v93, v125, v4
    v_fmac_f32 v94, v126, v4
    v_fmac_f32 v95, v127, v4
    s_and_saveexec_b64 s[56:57], vcc
    v_cvt_pk_bf16_f32 v20, v64, v65
    v_cvt_pk_bf16_f32 v21, v66, v67
    v_cvt_pk_bf16_f32 v22, v68, v69
    v_cvt_pk_bf16_f32 v23, v70, v71
    buffer_store_dwordx4 v[20:23], v12, s[36:39], 0 offen offset:0
    v_cvt_pk_bf16_f32 v24, v72, v73
    v_cvt_pk_bf16_f32 v25, v74, v75
    v_cvt_pk_bf16_f32 v26, v76, v77
    v_cvt_pk_bf16_f32 v27, v78, v79
    buffer_store_dwordx4 v[24:27], v12, s[36:39], 0 offen offset:512
    v_cvt_pk_bf16_f32 v28, v80, v81
    v_cvt_pk_bf16_f32 v29, v82, v83
    v_cvt_pk_bf16_f32 v30, v84, v85
    v_cvt_pk_bf16_f32 v31, v86, v87
    buffer_store_dwordx4 v[28:31], v12, s[36:39], 0 offen offset:1024
    v_cvt_pk_bf16_f32 v32, v88, v89
    v_cvt_pk_bf16_f32 v33, v90, v91
    v_cvt_pk_bf16_f32 v34, v92, v93
    v_cvt_pk_bf16_f32 v35, v94, v95
    buffer_store_dwordx4 v[32:35], v12, s[36:39], 0 offen offset:1536
    s_mov_b64 exec, s[56:57]
    s_endpgm
K1_UPD1:
    s_nop 7
    v_max_f32 v3, v13, v2
    v_sub_f32 v15, v13, v3
    v_mul_f32 v15, s47, v15
    v_exp_f32 v15, v15
    v_mov_b32 v13, v3
    v_mul_f32 v14, s52, v3
    s_nop 1
    v_mul_f32 v16, v16, v15
    v_mul_f32 v17, v17, v15
    v_mul_f32 v18, v18, v15
    v_mul_f32 v19, v19, v15
    s_mov_b32 s49, 1
    s_branch K1_UPDR1
K1_RES1:
    s_nop 15
    s_nop 15
    v_accvgpr_read_b32 v3, a0
    s_nop 0
    v_mul_f32 v3, v3, v15
    s_nop 0
    v_accvgpr_write_b32 a0, v3
    v_accvgpr_read_b32 v3, a1
    s_nop 0
    v_mul_f32 v3, v3, v15
    s_nop 0
    v_accvgpr_write_b32 a1, v3
    v_accvgpr_read_b32 v3, a2
    s_nop 0
    v_mul_f32 v3, v3, v15
    s_nop 0
    v_accvgpr_write_b32 a2, v3
    v_accvgpr_read_b32 v3, a3
    s_nop 0
    v_mul_f32 v3, v3, v15
    s_nop 0
    v_accvgpr_write_b32 a3, v3
    v_accvgpr_read_b32 v3, a4
    s_nop 0
    v_mul_f32 v3, v3, v15
    s_nop 0
    v_accvgpr_write_b32 a4, v3
    v_accvgpr_read_b32 v3, a5
    s_nop 0
    v_mul_f32 v3, v3, v15
    s_nop 0
    v_accvgpr_write_b32 a5, v3
    v_accvgpr_read_b32 v3, a6
    s_nop 0
    v_mul_f32 v3, v3, v15
    s_nop 0
    v_accvgpr_write_b32 a6, v3
    v_accvgpr_read_b32 v3, a7
    s_nop 0
    v_mul_f32 v3, v3, v15
    s_nop 0
    v_accvgpr_write_b32 a7, v3
    v_accvgpr_read_b32 v3, a8
    s_nop 0
    v_mul_f32 v3, v3, v15
    s_nop 0
    v_accvgpr_write_b32 a8, v3
    v_accvgpr_read_b32 v3, a9
    s_nop 0
    v_mul_f32 v3, v3, v15
    s_nop 0
    v_accvgpr_write_b32 a9, v3
    v_accvgpr_read_b32 v3, a10
    s_nop 0
    v_mul_f32 v3, v3, v15
    s_nop 0
    v_accvgpr_write_b32 a10, v3
    v_accvgpr_read_b32 v3, a11
    s_nop 0
    v_mul_f32 v3, v3, v15
    s_nop 0
    v_accvgpr_write_b32 a11, v3
    v_accvgpr_read_b32 v3, a12
    s_nop 0
    v_mul_f32 v3, v3, v15
    s_nop 0
    v_accvgpr_write_b32 a12, v3
    v_accvgpr_read_b32 v3, a13
    s_nop 0
    v_mul_f32 v3, v3, v15
    s_nop 0
    v_accvgpr_write_b32 a13, v3
    v_accvgpr_read_b32 v3, a14
    s_nop 0
    v_mul_f32 v3, v3, v15
    s_nop 0
    v_accvgpr_write_b32 a14, v3
    v_accvgpr_read_b32 v3, a15
    s_nop 0
    v_mul_f32 v3, v3, v15
    s_nop 0
    v_accvgpr_write_b32 a15, v3
    v_accvgpr_read_b32 v3, a16
    s_nop 0
    v_mul_f32 v3, v3, v15
    s_nop 0
    v_accvgpr_write_b32 a16, v3
    v_accvgpr_read_b32 v3, a17
    s_nop 0
    v_mul_f32 v3, v3, v15
    s_nop 0
    v_accvgpr_write_b32 a17, v3
    v_accvgpr_read_b32 v3, a18
    s_nop 0
    v_mul_f32 v3, v3, v15
    s_nop 0
    v_accvgpr_write_b32 a18, v3
    v_accvgpr_read_b32 v3, a19
    s_nop 0
    v_mul_f32 v3, v3, v15
    s_nop 0
    v_accvgpr_write_b32 a19, v3
    v_accvgpr_read_b32 v3, a20
    s_nop 0
    v_mul_f32 v3, v3, v15
    s_nop 0
    v_accvgpr_write_b32 a20, v3
    v_accvgpr_read_b32 v3, a21
    s_nop 0
    v_mul_f32 v3, v3, v15
    s_nop 0
    v_accvgpr_write_b32 a21, v3
    v_accvgpr_read_b32 v3, a22
    s_nop 0
    v_mul_f32 v3, v3, v15
    s_nop 0
    v_accvgpr_write_b32 a22, v3
    v_accvgpr_read_b32 v3, a23
    s_nop 0
    v_mul_f32 v3, v3, v15
    s_nop 0
    v_accvgpr_write_b32 a23, v3
    v_accvgpr_read_b32 v3, a24
    s_nop 0
    v_mul_f32 v3, v3, v15
    s_nop 0
    v_accvgpr_write_b32 a24, v3
    v_accvgpr_read_b32 v3, a25
    s_nop 0
    v_mul_f32 v3, v3, v15
    s_nop 0
    v_accvgpr_write_b32 a25, v3
    v_accvgpr_read_b32 v3, a26
    s_nop 0
    v_mul_f32 v3, v3, v15
    s_nop 0
    v_accvgpr_write_b32 a26, v3
    v_accvgpr_read_b32 v3, a27
    s_nop 0
    v_mul_f32 v3, v3, v15
    s_nop 0
    v_accvgpr_write_b32 a27, v3
    v_accvgpr_read_b32 v3, a28
    s_nop 0
    v_mul_f32 v3, v3, v15
    s_nop 0
    v_accvgpr_write_b32 a28, v3
    v_accvgpr_read_b32 v3, a29
    s_nop 0
    v_mul_f32 v3, v3, v15
    s_nop 0
    v_accvgpr_write_b32 a29, v3
    v_accvgpr_read_b32 v3, a30
    s_nop 0
    v_mul_f32 v3, v3, v15
    s_nop 0
    v_accvgpr_write_b32 a30, v3
    v_accvgpr_read_b32 v3, a31
    s_nop 0
    v_mul_f32 v3, v3, v15
    s_nop 0
    v_accvgpr_write_b32 a31, v3
    v_accvgpr_read_b32 v3, a32
    s_nop 0
    v_mul_f32 v3, v3, v15
    s_nop 0
    v_accvgpr_write_b32 a32, v3
    v_accvgpr_read_b32 v3, a33
    s_nop 0
    v_mul_f32 v3, v3, v15
    s_nop 0
    v_accvgpr_write_b32 a33, v3
    v_accvgpr_read_b32 v3, a34
    s_nop 0
    v_mul_f32 v3, v3, v15
    s_nop 0
    v_accvgpr_write_b32 a34, v3
    v_accvgpr_read_b32 v3, a35
    s_nop 0
    v_mul_f32 v3, v3, v15
    s_nop 0
    v_accvgpr_write_b32 a35, v3
    v_accvgpr_read_b32 v3, a36
    s_nop 0
    v_mul_f32 v3, v3, v15
    s_nop 0
    v_accvgpr_write_b32 a36, v3
    v_accvgpr_read_b32 v3, a37
    s_nop 0
    v_mul_f32 v3, v3, v15
    s_nop 0
    v_accvgpr_write_b32 a37, v3
    v_accvgpr_read_b32 v3, a38
    s_nop 0
    v_mul_f32 v3, v3, v15
    s_nop 0
    v_accvgpr_write_b32 a38, v3
    v_accvgpr_read_b32 v3, a39
    s_nop 0
    v_mul_f32 v3, v3, v15
    s_nop 0
    v_accvgpr_write_b32 a39, v3
    v_accvgpr_read_b32 v3, a40
    s_nop 0
    v_mul_f32 v3, v3, v15
    s_nop 0
    v_accvgpr_write_b32 a40, v3
    v_accvgpr_read_b32 v3, a41
    s_nop 0
    v_mul_f32 v3, v3, v15
    s_nop 0
    v_accvgpr_write_b32 a41, v3
    v_accvgpr_read_b32 v3, a42
    s_nop 0
    v_mul_f32 v3, v3, v15
    s_nop 0
    v_accvgpr_write_b32 a42, v3
    v_accvgpr_read_b32 v3, a43
    s_nop 0
    v_mul_f32 v3, v3, v15
    s_nop 0
    v_accvgpr_write_b32 a43, v3
    v_accvgpr_read_b32 v3, a44
    s_nop 0
    v_mul_f32 v3, v3, v15
    s_nop 0
    v_accvgpr_write_b32 a44, v3
    v_accvgpr_read_b32 v3, a45
    s_nop 0
    v_mul_f32 v3, v3, v15
    s_nop 0
    v_accvgpr_write_b32 a45, v3
    v_accvgpr_read_b32 v3, a46
    s_nop 0
    v_mul_f32 v3, v3, v15
    s_nop 0
    v_accvgpr_write_b32 a46, v3
    v_accvgpr_read_b32 v3, a47
    s_nop 0
    v_mul_f32 v3, v3, v15
    s_nop 0
    v_accvgpr_write_b32 a47, v3
    v_accvgpr_read_b32 v3, a48
    s_nop 0
    v_mul_f32 v3, v3, v15
    s_nop 0
    v_accvgpr_write_b32 a48, v3
    v_accvgpr_read_b32 v3, a49
    s_nop 0
    v_mul_f32 v3, v3, v15
    s_nop 0
    v_accvgpr_write_b32 a49, v3
    v_accvgpr_read_b32 v3, a50
    s_nop 0
    v_mul_f32 v3, v3, v15
    s_nop 0
    v_accvgpr_write_b32 a50, v3
    v_accvgpr_read_b32 v3, a51
    s_nop 0
    v_mul_f32 v3, v3, v15
    s_nop 0
    v_accvgpr_write_b32 a51, v3
    v_accvgpr_read_b32 v3, a52
    s_nop 0
    v_mul_f32 v3, v3, v15
    s_nop 0
    v_accvgpr_write_b32 a52, v3
    v_accvgpr_read_b32 v3, a53
    s_nop 0
    v_mul_f32 v3, v3, v15
    s_nop 0
    v_accvgpr_write_b32 a53, v3
    v_accvgpr_read_b32 v3, a54
    s_nop 0
    v_mul_f32 v3, v3, v15
    s_nop 0
    v_accvgpr_write_b32 a54, v3
    v_accvgpr_read_b32 v3, a55
    s_nop 0
    v_mul_f32 v3, v3, v15
    s_nop 0
    v_accvgpr_write_b32 a55, v3
    v_accvgpr_read_b32 v3, a56
    s_nop 0
    v_mul_f32 v3, v3, v15
    s_nop 0
    v_accvgpr_write_b32 a56, v3
    v_accvgpr_read_b32 v3, a57
    s_nop 0
    v_mul_f32 v3, v3, v15
    s_nop 0
    v_accvgpr_write_b32 a57, v3
    v_accvgpr_read_b32 v3, a58
    s_nop 0
    v_mul_f32 v3, v3, v15
    s_nop 0
    v_accvgpr_write_b32 a58, v3
    v_accvgpr_read_b32 v3, a59
    s_nop 0
    v_mul_f32 v3, v3, v15
    s_nop 0
    v_accvgpr_write_b32 a59, v3
    v_accvgpr_read_b32 v3, a60
    s_nop 0
    v_mul_f32 v3, v3, v15
    s_nop 0
    v_accvgpr_write_b32 a60, v3
    v_accvgpr_read_b32 v3, a61
    s_nop 0
    v_mul_f32 v3, v3, v15
    s_nop 0
    v_accvgpr_write_b32 a61, v3
    v_accvgpr_read_b32 v3, a62
    s_nop 0
    v_mul_f32 v3, v3, v15
    s_nop 0
    v_accvgpr_write_b32 a62, v3
    v_accvgpr_read_b32 v3, a63
    s_nop 0
    v_mul_f32 v3, v3, v15
    s_nop 0
    v_accvgpr_write_b32 a63, v3
    s_nop 7
    s_mov_b32 s49, 0
    s_branch K1_RESR1
K1_UPD2:
    s_nop 7
    v_max_f32 v3, v13, v2
    v_sub_f32 v15, v13, v3
    v_mul_f32 v15, s47, v15
    v_exp_f32 v15, v15
    v_mov_b32 v13, v3
    v_mul_f32 v14, s52, v3
    s_nop 1
    v_mul_f32 v16, v16, v15
    v_mul_f32 v17, v17, v15
    v_mul_f32 v18, v18, v15
    v_mul_f32 v19, v19, v15
    s_mov_b32 s49, 1
    s_branch K1_UPDR2
K1_RES2:
    s_nop 15
    s_nop 15
    v_accvgpr_read_b32 v3, a0
    s_nop 0
    v_mul_f32 v3, v3, v15
    s_nop 0
    v_accvgpr_write_b32 a0, v3
    v_accvgpr_read_b32 v3, a1
    s_nop 0
    v_mul_f32 v3, v3, v15
    s_nop 0
    v_accvgpr_write_b32 a1, v3
    v_accvgpr_read_b32 v3, a2
    s_nop 0
    v_mul_f32 v3, v3, v15
    s_nop 0
    v_accvgpr_write_b32 a2, v3
    v_accvgpr_read_b32 v3, a3
    s_nop 0
    v_mul_f32 v3, v3, v15
    s_nop 0
    v_accvgpr_write_b32 a3, v3
    v_accvgpr_read_b32 v3, a4
    s_nop 0
    v_mul_f32 v3, v3, v15
    s_nop 0
    v_accvgpr_write_b32 a4, v3
    v_accvgpr_read_b32 v3, a5
    s_nop 0
    v_mul_f32 v3, v3, v15
    s_nop 0
    v_accvgpr_write_b32 a5, v3
    v_accvgpr_read_b32 v3, a6
    s_nop 0
    v_mul_f32 v3, v3, v15
    s_nop 0
    v_accvgpr_write_b32 a6, v3
    v_accvgpr_read_b32 v3, a7
    s_nop 0
    v_mul_f32 v3, v3, v15
    s_nop 0
    v_accvgpr_write_b32 a7, v3
    v_accvgpr_read_b32 v3, a8
    s_nop 0
    v_mul_f32 v3, v3, v15
    s_nop 0
    v_accvgpr_write_b32 a8, v3
    v_accvgpr_read_b32 v3, a9
    s_nop 0
    v_mul_f32 v3, v3, v15
    s_nop 0
    v_accvgpr_write_b32 a9, v3
    v_accvgpr_read_b32 v3, a10
    s_nop 0
    v_mul_f32 v3, v3, v15
    s_nop 0
    v_accvgpr_write_b32 a10, v3
    v_accvgpr_read_b32 v3, a11
    s_nop 0
    v_mul_f32 v3, v3, v15
    s_nop 0
    v_accvgpr_write_b32 a11, v3
    v_accvgpr_read_b32 v3, a12
    s_nop 0
    v_mul_f32 v3, v3, v15
    s_nop 0
    v_accvgpr_write_b32 a12, v3
    v_accvgpr_read_b32 v3, a13
    s_nop 0
    v_mul_f32 v3, v3, v15
    s_nop 0
    v_accvgpr_write_b32 a13, v3
    v_accvgpr_read_b32 v3, a14
    s_nop 0
    v_mul_f32 v3, v3, v15
    s_nop 0
    v_accvgpr_write_b32 a14, v3
    v_accvgpr_read_b32 v3, a15
    s_nop 0
    v_mul_f32 v3, v3, v15
    s_nop 0
    v_accvgpr_write_b32 a15, v3
    v_accvgpr_read_b32 v3, a16
    s_nop 0
    v_mul_f32 v3, v3, v15
    s_nop 0
    v_accvgpr_write_b32 a16, v3
    v_accvgpr_read_b32 v3, a17
    s_nop 0
    v_mul_f32 v3, v3, v15
    s_nop 0
    v_accvgpr_write_b32 a17, v3
    v_accvgpr_read_b32 v3, a18
    s_nop 0
    v_mul_f32 v3, v3, v15
    s_nop 0
    v_accvgpr_write_b32 a18, v3
    v_accvgpr_read_b32 v3, a19
    s_nop 0
    v_mul_f32 v3, v3, v15
    s_nop 0
    v_accvgpr_write_b32 a19, v3
    v_accvgpr_read_b32 v3, a20
    s_nop 0
    v_mul_f32 v3, v3, v15
    s_nop 0
    v_accvgpr_write_b32 a20, v3
    v_accvgpr_read_b32 v3, a21
    s_nop 0
    v_mul_f32 v3, v3, v15
    s_nop 0
    v_accvgpr_write_b32 a21, v3
    v_accvgpr_read_b32 v3, a22
    s_nop 0
    v_mul_f32 v3, v3, v15
    s_nop 0
    v_accvgpr_write_b32 a22, v3
    v_accvgpr_read_b32 v3, a23
    s_nop 0
    v_mul_f32 v3, v3, v15
    s_nop 0
    v_accvgpr_write_b32 a23, v3
    v_accvgpr_read_b32 v3, a24
    s_nop 0
    v_mul_f32 v3, v3, v15
    s_nop 0
    v_accvgpr_write_b32 a24, v3
    v_accvgpr_read_b32 v3, a25
    s_nop 0
    v_mul_f32 v3, v3, v15
    s_nop 0
    v_accvgpr_write_b32 a25, v3
    v_accvgpr_read_b32 v3, a26
    s_nop 0
    v_mul_f32 v3, v3, v15
    s_nop 0
    v_accvgpr_write_b32 a26, v3
    v_accvgpr_read_b32 v3, a27
    s_nop 0
    v_mul_f32 v3, v3, v15
    s_nop 0
    v_accvgpr_write_b32 a27, v3
    v_accvgpr_read_b32 v3, a28
    s_nop 0
    v_mul_f32 v3, v3, v15
    s_nop 0
    v_accvgpr_write_b32 a28, v3
    v_accvgpr_read_b32 v3, a29
    s_nop 0
    v_mul_f32 v3, v3, v15
    s_nop 0
    v_accvgpr_write_b32 a29, v3
    v_accvgpr_read_b32 v3, a30
    s_nop 0
    v_mul_f32 v3, v3, v15
    s_nop 0
    v_accvgpr_write_b32 a30, v3
    v_accvgpr_read_b32 v3, a31
    s_nop 0
    v_mul_f32 v3, v3, v15
    s_nop 0
    v_accvgpr_write_b32 a31, v3
    v_accvgpr_read_b32 v3, a32
    s_nop 0
    v_mul_f32 v3, v3, v15
    s_nop 0
    v_accvgpr_write_b32 a32, v3
    v_accvgpr_read_b32 v3, a33
    s_nop 0
    v_mul_f32 v3, v3, v15
    s_nop 0
    v_accvgpr_write_b32 a33, v3
    v_accvgpr_read_b32 v3, a34
    s_nop 0
    v_mul_f32 v3, v3, v15
    s_nop 0
    v_accvgpr_write_b32 a34, v3
    v_accvgpr_read_b32 v3, a35
    s_nop 0
    v_mul_f32 v3, v3, v15
    s_nop 0
    v_accvgpr_write_b32 a35, v3
    v_accvgpr_read_b32 v3, a36
    s_nop 0
    v_mul_f32 v3, v3, v15
    s_nop 0
    v_accvgpr_write_b32 a36, v3
    v_accvgpr_read_b32 v3, a37
    s_nop 0
    v_mul_f32 v3, v3, v15
    s_nop 0
    v_accvgpr_write_b32 a37, v3
    v_accvgpr_read_b32 v3, a38
    s_nop 0
    v_mul_f32 v3, v3, v15
    s_nop 0
    v_accvgpr_write_b32 a38, v3
    v_accvgpr_read_b32 v3, a39
    s_nop 0
    v_mul_f32 v3, v3, v15
    s_nop 0
    v_accvgpr_write_b32 a39, v3
    v_accvgpr_read_b32 v3, a40
    s_nop 0
    v_mul_f32 v3, v3, v15
    s_nop 0
    v_accvgpr_write_b32 a40, v3
    v_accvgpr_read_b32 v3, a41
    s_nop 0
    v_mul_f32 v3, v3, v15
    s_nop 0
    v_accvgpr_write_b32 a41, v3
    v_accvgpr_read_b32 v3, a42
    s_nop 0
    v_mul_f32 v3, v3, v15
    s_nop 0
    v_accvgpr_write_b32 a42, v3
    v_accvgpr_read_b32 v3, a43
    s_nop 0
    v_mul_f32 v3, v3, v15
    s_nop 0
    v_accvgpr_write_b32 a43, v3
    v_accvgpr_read_b32 v3, a44
    s_nop 0
    v_mul_f32 v3, v3, v15
    s_nop 0
    v_accvgpr_write_b32 a44, v3
    v_accvgpr_read_b32 v3, a45
    s_nop 0
    v_mul_f32 v3, v3, v15
    s_nop 0
    v_accvgpr_write_b32 a45, v3
    v_accvgpr_read_b32 v3, a46
    s_nop 0
    v_mul_f32 v3, v3, v15
    s_nop 0
    v_accvgpr_write_b32 a46, v3
    v_accvgpr_read_b32 v3, a47
    s_nop 0
    v_mul_f32 v3, v3, v15
    s_nop 0
    v_accvgpr_write_b32 a47, v3
    v_accvgpr_read_b32 v3, a48
    s_nop 0
    v_mul_f32 v3, v3, v15
    s_nop 0
    v_accvgpr_write_b32 a48, v3
    v_accvgpr_read_b32 v3, a49
    s_nop 0
    v_mul_f32 v3, v3, v15
    s_nop 0
    v_accvgpr_write_b32 a49, v3
    v_accvgpr_read_b32 v3, a50
    s_nop 0
    v_mul_f32 v3, v3, v15
    s_nop 0
    v_accvgpr_write_b32 a50, v3
    v_accvgpr_read_b32 v3, a51
    s_nop 0
    v_mul_f32 v3, v3, v15
    s_nop 0
    v_accvgpr_write_b32 a51, v3
    v_accvgpr_read_b32 v3, a52
    s_nop 0
    v_mul_f32 v3, v3, v15
    s_nop 0
    v_accvgpr_write_b32 a52, v3
    v_accvgpr_read_b32 v3, a53
    s_nop 0
    v_mul_f32 v3, v3, v15
    s_nop 0
    v_accvgpr_write_b32 a53, v3
    v_accvgpr_read_b32 v3, a54
    s_nop 0
    v_mul_f32 v3, v3, v15
    s_nop 0
    v_accvgpr_write_b32 a54, v3
    v_accvgpr_read_b32 v3, a55
    s_nop 0
    v_mul_f32 v3, v3, v15
    s_nop 0
    v_accvgpr_write_b32 a55, v3
    v_accvgpr_read_b32 v3, a56
    s_nop 0
    v_mul_f32 v3, v3, v15
    s_nop 0
    v_accvgpr_write_b32 a56, v3
    v_accvgpr_read_b32 v3, a57
    s_nop 0
    v_mul_f32 v3, v3, v15
    s_nop 0
    v_accvgpr_write_b32 a57, v3
    v_accvgpr_read_b32 v3, a58
    s_nop 0
    v_mul_f32 v3, v3, v15
    s_nop 0
    v_accvgpr_write_b32 a58, v3
    v_accvgpr_read_b32 v3, a59
    s_nop 0
    v_mul_f32 v3, v3, v15
    s_nop 0
    v_accvgpr_write_b32 a59, v3
    v_accvgpr_read_b32 v3, a60
    s_nop 0
    v_mul_f32 v3, v3, v15
    s_nop 0
    v_accvgpr_write_b32 a60, v3
    v_accvgpr_read_b32 v3, a61
    s_nop 0
    v_mul_f32 v3, v3, v15
    s_nop 0
    v_accvgpr_write_b32 a61, v3
    v_accvgpr_read_b32 v3, a62
    s_nop 0
    v_mul_f32 v3, v3, v15
    s_nop 0
    v_accvgpr_write_b32 a62, v3
    v_accvgpr_read_b32 v3, a63
    s_nop 0
    v_mul_f32 v3, v3, v15
    s_nop 0
    v_accvgpr_write_b32 a63, v3
    s_nop 7
    s_mov_b32 s49, 0
    s_branch K1_RESR2
K1_UPD3:
    s_nop 7
    v_max_f32 v3, v13, v2
    v_sub_f32 v15, v13, v3
    v_mul_f32 v15, s47, v15
    v_exp_f32 v15, v15
    v_mov_b32 v13, v3
    v_mul_f32 v14, s52, v3
    s_nop 1
    v_mul_f32 v16, v16, v15
    v_mul_f32 v17, v17, v15
    v_mul_f32 v18, v18, v15
    v_mul_f32 v19, v19, v15
    s_mov_b32 s49, 1
    s_branch K1_UPDR3
K1_RES3:
    s_nop 15
    s_nop 15
    v_accvgpr_read_b32 v3, a0
    s_nop 0
    v_mul_f32 v3, v3, v15
    s_nop 0
    v_accvgpr_write_b32 a0, v3
    v_accvgpr_read_b32 v3, a1
    s_nop 0
    v_mul_f32 v3, v3, v15
    s_nop 0
    v_accvgpr_write_b32 a1, v3
    v_accvgpr_read_b32 v3, a2
    s_nop 0
    v_mul_f32 v3, v3, v15
    s_nop 0
    v_accvgpr_write_b32 a2, v3
    v_accvgpr_read_b32 v3, a3
    s_nop 0
    v_mul_f32 v3, v3, v15
    s_nop 0
    v_accvgpr_write_b32 a3, v3
    v_accvgpr_read_b32 v3, a4
    s_nop 0
    v_mul_f32 v3, v3, v15
    s_nop 0
    v_accvgpr_write_b32 a4, v3
    v_accvgpr_read_b32 v3, a5
    s_nop 0
    v_mul_f32 v3, v3, v15
    s_nop 0
    v_accvgpr_write_b32 a5, v3
    v_accvgpr_read_b32 v3, a6
    s_nop 0
    v_mul_f32 v3, v3, v15
    s_nop 0
    v_accvgpr_write_b32 a6, v3
    v_accvgpr_read_b32 v3, a7
    s_nop 0
    v_mul_f32 v3, v3, v15
    s_nop 0
    v_accvgpr_write_b32 a7, v3
    v_accvgpr_read_b32 v3, a8
    s_nop 0
    v_mul_f32 v3, v3, v15
    s_nop 0
    v_accvgpr_write_b32 a8, v3
    v_accvgpr_read_b32 v3, a9
    s_nop 0
    v_mul_f32 v3, v3, v15
    s_nop 0
    v_accvgpr_write_b32 a9, v3
    v_accvgpr_read_b32 v3, a10
    s_nop 0
    v_mul_f32 v3, v3, v15
    s_nop 0
    v_accvgpr_write_b32 a10, v3
    v_accvgpr_read_b32 v3, a11
    s_nop 0
    v_mul_f32 v3, v3, v15
    s_nop 0
    v_accvgpr_write_b32 a11, v3
    v_accvgpr_read_b32 v3, a12
    s_nop 0
    v_mul_f32 v3, v3, v15
    s_nop 0
    v_accvgpr_write_b32 a12, v3
    v_accvgpr_read_b32 v3, a13
    s_nop 0
    v_mul_f32 v3, v3, v15
    s_nop 0
    v_accvgpr_write_b32 a13, v3
    v_accvgpr_read_b32 v3, a14
    s_nop 0
    v_mul_f32 v3, v3, v15
    s_nop 0
    v_accvgpr_write_b32 a14, v3
    v_accvgpr_read_b32 v3, a15
    s_nop 0
    v_mul_f32 v3, v3, v15
    s_nop 0
    v_accvgpr_write_b32 a15, v3
    v_accvgpr_read_b32 v3, a16
    s_nop 0
    v_mul_f32 v3, v3, v15
    s_nop 0
    v_accvgpr_write_b32 a16, v3
    v_accvgpr_read_b32 v3, a17
    s_nop 0
    v_mul_f32 v3, v3, v15
    s_nop 0
    v_accvgpr_write_b32 a17, v3
    v_accvgpr_read_b32 v3, a18
    s_nop 0
    v_mul_f32 v3, v3, v15
    s_nop 0
    v_accvgpr_write_b32 a18, v3
    v_accvgpr_read_b32 v3, a19
    s_nop 0
    v_mul_f32 v3, v3, v15
    s_nop 0
    v_accvgpr_write_b32 a19, v3
    v_accvgpr_read_b32 v3, a20
    s_nop 0
    v_mul_f32 v3, v3, v15
    s_nop 0
    v_accvgpr_write_b32 a20, v3
    v_accvgpr_read_b32 v3, a21
    s_nop 0
    v_mul_f32 v3, v3, v15
    s_nop 0
    v_accvgpr_write_b32 a21, v3
    v_accvgpr_read_b32 v3, a22
    s_nop 0
    v_mul_f32 v3, v3, v15
    s_nop 0
    v_accvgpr_write_b32 a22, v3
    v_accvgpr_read_b32 v3, a23
    s_nop 0
    v_mul_f32 v3, v3, v15
    s_nop 0
    v_accvgpr_write_b32 a23, v3
    v_accvgpr_read_b32 v3, a24
    s_nop 0
    v_mul_f32 v3, v3, v15
    s_nop 0
    v_accvgpr_write_b32 a24, v3
    v_accvgpr_read_b32 v3, a25
    s_nop 0
    v_mul_f32 v3, v3, v15
    s_nop 0
    v_accvgpr_write_b32 a25, v3
    v_accvgpr_read_b32 v3, a26
    s_nop 0
    v_mul_f32 v3, v3, v15
    s_nop 0
    v_accvgpr_write_b32 a26, v3
    v_accvgpr_read_b32 v3, a27
    s_nop 0
    v_mul_f32 v3, v3, v15
    s_nop 0
    v_accvgpr_write_b32 a27, v3
    v_accvgpr_read_b32 v3, a28
    s_nop 0
    v_mul_f32 v3, v3, v15
    s_nop 0
    v_accvgpr_write_b32 a28, v3
    v_accvgpr_read_b32 v3, a29
    s_nop 0
    v_mul_f32 v3, v3, v15
    s_nop 0
    v_accvgpr_write_b32 a29, v3
    v_accvgpr_read_b32 v3, a30
    s_nop 0
    v_mul_f32 v3, v3, v15
    s_nop 0
    v_accvgpr_write_b32 a30, v3
    v_accvgpr_read_b32 v3, a31
    s_nop 0
    v_mul_f32 v3, v3, v15
    s_nop 0
    v_accvgpr_write_b32 a31, v3
    v_accvgpr_read_b32 v3, a32
    s_nop 0
    v_mul_f32 v3, v3, v15
    s_nop 0
    v_accvgpr_write_b32 a32, v3
    v_accvgpr_read_b32 v3, a33
    s_nop 0
    v_mul_f32 v3, v3, v15
    s_nop 0
    v_accvgpr_write_b32 a33, v3
    v_accvgpr_read_b32 v3, a34
    s_nop 0
    v_mul_f32 v3, v3, v15
    s_nop 0
    v_accvgpr_write_b32 a34, v3
    v_accvgpr_read_b32 v3, a35
    s_nop 0
    v_mul_f32 v3, v3, v15
    s_nop 0
    v_accvgpr_write_b32 a35, v3
    v_accvgpr_read_b32 v3, a36
    s_nop 0
    v_mul_f32 v3, v3, v15
    s_nop 0
    v_accvgpr_write_b32 a36, v3
    v_accvgpr_read_b32 v3, a37
    s_nop 0
    v_mul_f32 v3, v3, v15
    s_nop 0
    v_accvgpr_write_b32 a37, v3
    v_accvgpr_read_b32 v3, a38
    s_nop 0
    v_mul_f32 v3, v3, v15
    s_nop 0
    v_accvgpr_write_b32 a38, v3
    v_accvgpr_read_b32 v3, a39
    s_nop 0
    v_mul_f32 v3, v3, v15
    s_nop 0
    v_accvgpr_write_b32 a39, v3
    v_accvgpr_read_b32 v3, a40
    s_nop 0
    v_mul_f32 v3, v3, v15
    s_nop 0
    v_accvgpr_write_b32 a40, v3
    v_accvgpr_read_b32 v3, a41
    s_nop 0
    v_mul_f32 v3, v3, v15
    s_nop 0
    v_accvgpr_write_b32 a41, v3
    v_accvgpr_read_b32 v3, a42
    s_nop 0
    v_mul_f32 v3, v3, v15
    s_nop 0
    v_accvgpr_write_b32 a42, v3
    v_accvgpr_read_b32 v3, a43
    s_nop 0
    v_mul_f32 v3, v3, v15
    s_nop 0
    v_accvgpr_write_b32 a43, v3
    v_accvgpr_read_b32 v3, a44
    s_nop 0
    v_mul_f32 v3, v3, v15
    s_nop 0
    v_accvgpr_write_b32 a44, v3
    v_accvgpr_read_b32 v3, a45
    s_nop 0
    v_mul_f32 v3, v3, v15
    s_nop 0
    v_accvgpr_write_b32 a45, v3
    v_accvgpr_read_b32 v3, a46
    s_nop 0
    v_mul_f32 v3, v3, v15
    s_nop 0
    v_accvgpr_write_b32 a46, v3
    v_accvgpr_read_b32 v3, a47
    s_nop 0
    v_mul_f32 v3, v3, v15
    s_nop 0
    v_accvgpr_write_b32 a47, v3
    v_accvgpr_read_b32 v3, a48
    s_nop 0
    v_mul_f32 v3, v3, v15
    s_nop 0
    v_accvgpr_write_b32 a48, v3
    v_accvgpr_read_b32 v3, a49
    s_nop 0
    v_mul_f32 v3, v3, v15
    s_nop 0
    v_accvgpr_write_b32 a49, v3
    v_accvgpr_read_b32 v3, a50
    s_nop 0
    v_mul_f32 v3, v3, v15
    s_nop 0
    v_accvgpr_write_b32 a50, v3
    v_accvgpr_read_b32 v3, a51
    s_nop 0
    v_mul_f32 v3, v3, v15
    s_nop 0
    v_accvgpr_write_b32 a51, v3
    v_accvgpr_read_b32 v3, a52
    s_nop 0
    v_mul_f32 v3, v3, v15
    s_nop 0
    v_accvgpr_write_b32 a52, v3
    v_accvgpr_read_b32 v3, a53
    s_nop 0
    v_mul_f32 v3, v3, v15
    s_nop 0
    v_accvgpr_write_b32 a53, v3
    v_accvgpr_read_b32 v3, a54
    s_nop 0
    v_mul_f32 v3, v3, v15
    s_nop 0
    v_accvgpr_write_b32 a54, v3
    v_accvgpr_read_b32 v3, a55
    s_nop 0
    v_mul_f32 v3, v3, v15
    s_nop 0
    v_accvgpr_write_b32 a55, v3
    v_accvgpr_read_b32 v3, a56
    s_nop 0
    v_mul_f32 v3, v3, v15
    s_nop 0
    v_accvgpr_write_b32 a56, v3
    v_accvgpr_read_b32 v3, a57
    s_nop 0
    v_mul_f32 v3, v3, v15
    s_nop 0
    v_accvgpr_write_b32 a57, v3
    v_accvgpr_read_b32 v3, a58
    s_nop 0
    v_mul_f32 v3, v3, v15
    s_nop 0
    v_accvgpr_write_b32 a58, v3
    v_accvgpr_read_b32 v3, a59
    s_nop 0
    v_mul_f32 v3, v3, v15
    s_nop 0
    v_accvgpr_write_b32 a59, v3
    v_accvgpr_read_b32 v3, a60
    s_nop 0
    v_mul_f32 v3, v3, v15
    s_nop 0
    v_accvgpr_write_b32 a60, v3
    v_accvgpr_read_b32 v3, a61
    s_nop 0
    v_mul_f32 v3, v3, v15
    s_nop 0
    v_accvgpr_write_b32 a61, v3
    v_accvgpr_read_b32 v3, a62
    s_nop 0
    v_mul_f32 v3, v3, v15
    s_nop 0
    v_accvgpr_write_b32 a62, v3
    v_accvgpr_read_b32 v3, a63
    s_nop 0
    v_mul_f32 v3, v3, v15
    s_nop 0
    v_accvgpr_write_b32 a63, v3
    s_nop 7
    s_mov_b32 s49, 0
    s_branch K1_RESR3
K1_END:
    s_endpgm
.globl oproj_kernel
.p2align 8
.type oproj_kernel,@function
oproj_kernel:
    s_cmp_ge_u32 s2, 256
    s_cbranch_scc1 K2_END
    s_load_dwordx4 s[4:7], s[0:1], 32
    s_load_dwordx2 s[10:11], s[0:1], 56
    s_and_b32 s40, s2, 7
    s_lshr_b32 s41, s2, 3
    s_lshl_b32 s40, s40, 5
    s_add_u32 s40, s40, s41
    s_lshr_b32 s41, s40, 6
    s_and_b32 s42, s40, 63
    s_cmp_eq_u32 s42, 63
    s_cbranch_scc1 K2_END
    s_mul_i32 s43, s42, 37
    s_lshr_b32 s43, s43, 8
    s_mul_i32 s44, s43, 7
    s_sub_u32 s44, s42, s44
    s_mul_i32 s45, s41, 7
    s_add_u32 s44, s44, s45
    v_lshrrev_b32 v2, 6, v0
    v_and_b32 v1, 63, v0
    v_readfirstlane_b32 s46, v2
    s_nop 1
    s_mul_i32 s47, s46, 20480
    v_bfe_u32 v3, v1, 4, 1
    v_lshrrev_b32 v4, 5, v1
    v_and_b32 v5, 15, v1
    v_lshlrev_b32 v8, 17, v3
    v_lshl_add_u32 v8, v4, 8, v8
    v_lshl_add_u32 v8, v5, 4, v8
    s_lshl_b32 s48, s44, 18
    s_lshl_b32 s49, s46, 14
    s_add_u32 s48, s48, s49
    v_add_u32 v8, s48, v8
    v_lshrrev_b32 v6, 3, v1
    v_and_b32 v7, 7, v1
    v_bfe_u32 v11, v1, 4, 1
    v_lshlrev_b32 v11, 2, v11
    v_xor_b32 v11, v11, v7
    v_mul_u32_u24 v9, 1152, v6
    v_lshl_add_u32 v9, v11, 4, v9
    s_lshl_b32 s51, s43, 7
    v_add_u32 v9, s51, v9
    s_mul_i32 s52, s46, 589824
    s_waitcnt lgkmcnt(0)
    s_mov_b32 s16, s10
    s_and_b32 s17, s11, 0xffff
    s_mov_b32 s18, 67108864
    s_mov_b32 s19, 0x00020000
    s_mov_b32 s20, s4
    s_and_b32 s21, s5, 0xffff
    s_mov_b32 s22, 4718592
    s_mov_b32 s23, 0x00020000
    s_mov_b32 s24, s6
    s_and_b32 s25, s7, 0xffff
    s_mov_b32 s26, 1032192
    s_mov_b32 s27, 0x00020000
    s_mov_b32 s54, 0
    buffer_load_dwordx4 a[0:3], v8, s[16:19], s54 offen offset:0
    s_mov_b32 s54, 0
    buffer_load_dwordx4 a[4:7], v8, s[16:19], s54 offen offset:512
    s_add_u32 m0, s47, 0
    s_add_u32 s53, s52, 0
    buffer_load_dwordx4 v9, s[20:23], s53 offen lds
    s_add_u32 m0, s47, 1024
    s_add_u32 s53, s52, 9216
    buffer_load_dwordx4 v9, s[20:23], s53 offen lds
    s_add_u32 m0, s47, 2048
    s_add_u32 s53, s52, 18432
    buffer_load_dwordx4 v9, s[20:23], s53 offen lds
    s_add_u32 m0, s47, 3072
    s_add_u32 s53, s52, 27648
    buffer_load_dwordx4 v9, s[20:23], s53 offen lds
    s_mov_b32 s54, 0
    buffer_load_dwordx4 a[8:11], v8, s[16:19], s54 offen offset:1024
    s_mov_b32 s54, 0
    buffer_load_dwordx4 a[12:15], v8, s[16:19], s54 offen offset:1536
    s_add_u32 m0, s47, 4096
    s_add_u32 s53, s52, 36864
    buffer_load_dwordx4 v9, s[20:23], s53 offen lds
    s_add_u32 m0, s47, 5120
    s_add_u32 s53, s52, 46080
    buffer_load_dwordx4 v9, s[20:23], s53 offen lds
    s_add_u32 m0, s47, 6144
    s_add_u32 s53, s52, 55296
    buffer_load_dwordx4 v9, s[20:23], s53 offen lds
    s_add_u32 m0, s47, 7168
    s_add_u32 s53, s52, 64512
    buffer_load_dwordx4 v9, s[20:23], s53 offen lds
    s_mov_b32 s54, 0
    buffer_load_dwordx4 a[16:19], v8, s[16:19], s54 offen offset:2048
    s_mov_b32 s54, 0
    buffer_load_dwordx4 a[20:23], v8, s[16:19], s54 offen offset:2560
    s_add_u32 m0, s47, 8192
    s_add_u32 s53, s52, 73728
    buffer_load_dwordx4 v9, s[20:23], s53 offen lds
    s_add_u32 m0, s47, 9216
    s_add_u32 s53, s52, 82944
    buffer_load_dwordx4 v9, s[20:23], s53 offen lds
    s_add_u32 m0, s47, 10240
    s_add_u32 s53, s52, 92160
    buffer_load_dwordx4 v9, s[20:23], s53 offen lds
    s_add_u32 m0, s47, 11264
    s_add_u32 s53, s52, 101376
    buffer_load_dwordx4 v9, s[20:23], s53 offen lds
    s_mov_b32 s54, 0
    buffer_load_dwordx4 a[24:27], v8, s[16:19], s54 offen offset:3072
    s_mov_b32 s54, 0
    buffer_load_dwordx4 a[28:31], v8, s[16:19], s54 offen offset:3584
    s_add_u32 m0, s47, 12288
    s_add_u32 s53, s52, 110592
    buffer_load_dwordx4 v9, s[20:23], s53 offen lds
    s_add_u32 m0, s47, 13312
    s_add_u32 s53, s52, 119808
    buffer_load_dwordx4 v9, s[20:23], s53 offen lds
    s_add_u32 m0, s47, 14336
    s_add_u32 s53, s52, 129024
    buffer_load_dwordx4 v9, s[20:23], s53 offen lds
    s_add_u32 m0, s47, 15360
    s_add_u32 s53, s52, 138240
    buffer_load_dwordx4 v9, s[20:23], s53 offen lds
    s_mov_b32 s54, 4096
    buffer_load_dwordx4 a[32:35], v8, s[16:19], s54 offen offset:0
    s_mov_b32 s54, 4096
    buffer_load_dwordx4 a[36:39], v8, s[16:19], s54 offen offset:512
    s_add_u32 m0, s47, 16384
    s_add_u32 s53, s52, 147456
    buffer_load_dwordx4 v9, s[20:23], s53 offen lds
    s_add_u32 m0, s47, 17408
    s_add_u32 s53, s52, 156672
    buffer_load_dwordx4 v9, s[20:23], s53 offen lds
    s_add_u32 m0, s47, 18432
    s_add_u32 s53, s52, 165888
    buffer_load_dwordx4 v9, s[20:23], s53 offen lds
    s_add_u32 m0, s47, 19456
    s_add_u32 s53, s52, 175104
    buffer_load_dwordx4 v9, s[20:23], s53 offen lds
    v_bfe_u32 v11, v1, 4, 1
    v_bfe_u32 v12, v1, 2, 2
    v_and_b32 v13, 1, v1
    v_bfe_u32 v14, v1, 1, 1
    v_lshl_add_u32 v15, v4, 3, v12
    v_lshlrev_b32 v15, 7, v15
    v_lshl_add_u32 v15, v11, 5, v15
    v_lshl_add_u32 v15, v13, 4, v15
    v_lshl_add_u32 v15, v14, 3, v15
    v_add_u32 v15, s47, v15
    v_lshrrev_b32 v12, 1, v12
    v_xor_b32 v2, 0, v12
    v_lshl_add_u32 v24, v2, 6, v15
    v_xor_b32 v2, 1, v12
    v_lshl_add_u32 v25, v2, 6, v15
    s_waitcnt vmcnt(24)
    ds_read_b64_tr_b16 v[64:65], v24 offset:0
    ds_read_b64_tr_b16 v[66:67], v24 offset:512
    ds_read_b64_tr_b16 v[68:69], v25 offset:0
    ds_read_b64_tr_b16 v[70:71], v25 offset:512
    ds_read_b64_tr_b16 v[72:73], v24 offset:2048
    ds_read_b64_tr_b16 v[74:75], v24 offset:2560
    ds_read_b64_tr_b16 v[76:77], v25 offset:2048
    ds_read_b64_tr_b16 v[78:79], v25 offset:2560
    s_waitcnt vmcnt(18)
    ds_read_b64_tr_b16 v[80:81], v24 offset:4096
    ds_read_b64_tr_b16 v[82:83], v24 offset:4608
    s_waitcnt lgkmcnt(8)
    v_mfma_f32_32x32x16_bf16 v[32:47], v[64:67], a[0:3], 0
    ds_read_b64_tr_b16 v[84:85], v25 offset:4096
    ds_read_b64_tr_b16 v[86:87], v25 offset:4608
    s_waitcnt lgkmcnt(8)
    v_mfma_f32_32x32x16_bf16 v[48:63], v[68:71], a[0:3], 0
    ds_read_b64_tr_b16 v[88:89], v24 offset:6144
    ds_read_b64_tr_b16 v[90:91], v24 offset:6656
    s_waitcnt lgkmcnt(8)
    v_mfma_f32_32x32x16_bf16 v[32:47], v[72:75], a[4:7], v[32:47]
    ds_read_b64_tr_b16 v[92:93], v25 offset:6144
    ds_read_b64_tr_b16 v[94:95], v25 offset:6656
    s_waitcnt lgkmcnt(8)
    v_mfma_f32_32x32x16_bf16 v[48:63], v[76:79], a[4:7], v[48:63]
    s_mov_b32 s54, 4096
    buffer_load_dwordx4 a[40:43], v8, s[16:19], s54 offen offset:1024
    s_mov_b32 s54, 4096
    buffer_load_dwordx4 a[44:47], v8, s[16:19], s54 offen offset:1536
    s_add_u32 m0, s47, 0
    s_add_u32 s53, s52, 184320
    buffer_load_dwordx4 v9, s[20:23], s53 offen lds
    s_add_u32 m0, s47, 1024
    s_add_u32 s53, s52, 193536
    buffer_load_dwordx4 v9, s[20:23], s53 offen lds
    s_add_u32 m0, s47, 2048
    s_add_u32 s53, s52, 202752
    buffer_load_dwordx4 v9, s[20:23], s53 offen lds
    s_add_u32 m0, s47, 3072
    s_add_u32 s53, s52, 211968
    buffer_load_dwordx4 v9, s[20:23], s53 offen lds
    s_waitcnt vmcnt(18)
    ds_read_b64_tr_b16 v[96:97], v24 offset:8192
    ds_read_b64_tr_b16 v[98:99], v24 offset:8704
    s_waitcnt lgkmcnt(8)
    v_mfma_f32_32x32x16_bf16 v[32:47], v[80:83], a[8:11], v[32:47]
    ds_read_b64_tr_b16 v[100:101], v25 offset:8192
    ds_read_b64_tr_b16 v[102:103], v25 offset:8704
    s_waitcnt lgkmcnt(8)
    v_mfma_f32_32x32x16_bf16 v[48:63], v[84:87], a[8:11], v[48:63]
    ds_read_b64_tr_b16 v[64:65], v24 offset:10240
    ds_read_b64_tr_b16 v[66:67], v24 offset:10752
    s_waitcnt lgkmcnt(8)
    v_mfma_f32_32x32x16_bf16 v[32:47], v[88:91], a[12:15], v[32:47]
    ds_read_b64_tr_b16 v[68:69], v25 offset:10240
    ds_read_b64_tr_b16 v[70:71], v25 offset:10752
    s_waitcnt lgkmcnt(8)
    v_mfma_f32_32x32x16_bf16 v[48:63], v[92:95], a[12:15], v[48:63]
    s_mov_b32 s54, 4096
    buffer_load_dwordx4 a[48:51], v8, s[16:19], s54 offen offset:2048
    s_mov_b32 s54, 4096
    buffer_load_dwordx4 a[52:55], v8, s[16:19], s54 offen offset:2560
    s_add_u32 m0, s47, 4096
    s_add_u32 s53, s52, 221184
    buffer_load_dwordx4 v9, s[20:23], s53 offen lds
    s_add_u32 m0, s47, 5120
    s_add_u32 s53, s52, 230400
    buffer_load_dwordx4 v9, s[20:23], s53 offen lds
    s_add_u32 m0, s47, 6144
    s_add_u32 s53, s52, 239616
    buffer_load_dwordx4 v9, s[20:23], s53 offen lds
    s_add_u32 m0, s47, 7168
    s_add_u32 s53, s52, 248832
    buffer_load_dwordx4 v9, s[20:23], s53 offen lds
    s_waitcnt vmcnt(18)
    ds_read_b64_tr_b16 v[72:73], v24 offset:12288
    ds_read_b64_tr_b16 v[74:75], v24 offset:12800
    s_waitcnt lgkmcnt(8)
    v_mfma_f32_32x32x16_bf16 v[32:47], v[96:99], a[16:19], v[32:47]
    ds_read_b64_tr_b16 v[76:77], v25 offset:12288
    ds_read_b64_tr_b16 v[78:79], v25 offset:12800
    s_waitcnt lgkmcnt(8)
    v_mfma_f32_32x32x16_bf16 v[48:63], v[100:103], a[16:19], v[48:63]
    ds_read_b64_tr_b16 v[80:81], v24 offset:14336
    ds_read_b64_tr_b16 v[82:83], v24 offset:14848
    s_waitcnt lgkmcnt(8)
    v_mfma_f32_32x32x16_bf16 v[32:47], v[64:67], a[20:23], v[32:47]
    ds_read_b64_tr_b16 v[84:85], v25 offset:14336
    ds_read_b64_tr_b16 v[86:87], v25 offset:14848
    s_waitcnt lgkmcnt(8)
    v_mfma_f32_32x32x16_bf16 v[48:63], v[68:71], a[20:23], v[48:63]
    s_mov_b32 s54, 4096
    buffer_load_dwordx4 a[56:59], v8, s[16:19], s54 offen offset:3072
    s_mov_b32 s54, 4096
    buffer_load_dwordx4 a[60:63], v8, s[16:19], s54 offen offset:3584
    s_add_u32 m0, s47, 8192
    s_add_u32 s53, s52, 258048
    buffer_load_dwordx4 v9, s[20:23], s53 offen lds
    s_add_u32 m0, s47, 9216
    s_add_u32 s53, s52, 267264
    buffer_load_dwordx4 v9, s[20:23], s53 offen lds
    s_add_u32 m0, s47, 10240
    s_add_u32 s53, s52, 276480
    buffer_load_dwordx4 v9, s[20:23], s53 offen lds
    s_add_u32 m0, s47, 11264
    s_add_u32 s53, s52, 285696
    buffer_load_dwordx4 v9, s[20:23], s53 offen lds
    s_waitcnt vmcnt(18)
    ds_read_b64_tr_b16 v[88:89], v24 offset:16384
    ds_read_b64_tr_b16 v[90:91], v24 offset:16896
    s_waitcnt lgkmcnt(8)
    v_mfma_f32_32x32x16_bf16 v[32:47], v[72:75], a[24:27], v[32:47]
    ds_read_b64_tr_b16 v[92:93], v25 offset:16384
    ds_read_b64_tr_b16 v[94:95], v25 offset:16896
    s_waitcnt lgkmcnt(8)
    v_mfma_f32_32x32x16_bf16 v[48:63], v[76:79], a[24:27], v[48:63]
    ds_read_b64_tr_b16 v[96:97], v24 offset:18432
    ds_read_b64_tr_b16 v[98:99], v24 offset:18944
    s_waitcnt lgkmcnt(8)
    v_mfma_f32_32x32x16_bf16 v[32:47], v[80:83], a[28:31], v[32:47]
    ds_read_b64_tr_b16 v[100:101], v25 offset:18432
    ds_read_b64_tr_b16 v[102:103], v25 offset:18944
    s_waitcnt lgkmcnt(8)
    v_mfma_f32_32x32x16_bf16 v[48:63], v[84:87], a[28:31], v[48:63]
    s_mov_b32 s54, 8192
    buffer_load_dwordx4 a[64:67], v8, s[16:19], s54 offen offset:0
    s_mov_b32 s54, 8192
    buffer_load_dwordx4 a[68:71], v8, s[16:19], s54 offen offset:512
    s_add_u32 m0, s47, 12288
    s_add_u32 s53, s52, 294912
    buffer_load_dwordx4 v9, s[20:23], s53 offen lds
    s_add_u32 m0, s47, 13312
    s_add_u32 s53, s52, 304128
    buffer_load_dwordx4 v9, s[20:23], s53 offen lds
    s_add_u32 m0, s47, 14336
    s_add_u32 s53, s52, 313344
    buffer_load_dwordx4 v9, s[20:23], s53 offen lds
    s_add_u32 m0, s47, 15360
    s_add_u32 s53, s52, 322560
    buffer_load_dwordx4 v9, s[20:23], s53 offen lds
    s_waitcnt vmcnt(18)
    ds_read_b64_tr_b16 v[64:65], v24 offset:0
    ds_read_b64_tr_b16 v[66:67], v24 offset:512
    s_waitcnt lgkmcnt(8)
    v_mfma_f32_32x32x16_bf16 v[32:47], v[88:91], a[32:35], v[32:47]
    ds_read_b64_tr_b16 v[68:69], v25 offset:0
    ds_read_b64_tr_b16 v[70:71], v25 offset:512
    s_waitcnt lgkmcnt(8)
    v_mfma_f32_32x32x16_bf16 v[48:63], v[92:95], a[32:35], v[48:63]
    ds_read_b64_tr_b16 v[72:73], v24 offset:2048
    ds_read_b64_tr_b16 v[74:75], v24 offset:2560
    s_waitcnt lgkmcnt(8)
    v_mfma_f32_32x32x16_bf16 v[32:47], v[96:99], a[36:39], v[32:47]
    ds_read_b64_tr_b16 v[76:77], v25 offset:2048
    ds_read_b64_tr_b16 v[78:79], v25 offset:2560
    s_waitcnt lgkmcnt(8)
    v_mfma_f32_32x32x16_bf16 v[48:63], v[100:103], a[36:39], v[48:63]
    s_mov_b32 s54, 8192
    buffer_load_dwordx4 a[72:75], v8, s[16:19], s54 offen offset:1024
    s_mov_b32 s54, 8192
    buffer_load_dwordx4 a[76:79], v8, s[16:19], s54 offen offset:1536
    s_add_u32 m0, s47, 16384
    s_add_u32 s53, s52, 331776
    buffer_load_dwordx4 v9, s[20:23], s53 offen lds
    s_add_u32 m0, s47, 17408
    s_add_u32 s53, s52, 340992
    buffer_load_dwordx4 v9, s[20:23], s53 offen lds
    s_add_u32 m0, s47, 18432
    s_add_u32 s53, s52, 350208
    buffer_load_dwordx4 v9, s[20:23], s53 offen lds
    s_add_u32 m0, s47, 19456
    s_add_u32 s53, s52, 359424
    buffer_load_dwordx4 v9, s[20:23], s53 offen lds
    s_waitcnt vmcnt(18)
    ds_read_b64_tr_b16 v[80:81], v24 offset:4096
    ds_read_b64_tr_b16 v[82:83], v24 offset:4608
    s_waitcnt lgkmcnt(8)
    v_mfma_f32_32x32x16_bf16 v[32:47], v[64:67], a[40:43], v[32:47]
    ds_read_b64_tr_b16 v[84:85], v25 offset:4096
    ds_read_b64_tr_b16 v[86:87], v25 offset:4608
    s_waitcnt lgkmcnt(8)
    v_mfma_f32_32x32x16_bf16 v[48:63], v[68:71], a[40:43], v[48:63]
    ds_read_b64_tr_b16 v[88:89], v24 offset:6144
    ds_read_b64_tr_b16 v[90:91], v24 offset:6656
    s_waitcnt lgkmcnt(8)
    v_mfma_f32_32x32x16_bf16 v[32:47], v[72:75], a[44:47], v[32:47]
    ds_read_b64_tr_b16 v[92:93], v25 offset:6144
    ds_read_b64_tr_b16 v[94:95], v25 offset:6656
    s_waitcnt lgkmcnt(8)
    v_mfma_f32_32x32x16_bf16 v[48:63], v[76:79], a[44:47], v[48:63]
    s_mov_b32 s54, 8192
    buffer_load_dwordx4 a[80:83], v8, s[16:19], s54 offen offset:2048
    s_mov_b32 s54, 8192
    buffer_load_dwordx4 a[84:87], v8, s[16:19], s54 offen offset:2560
    s_add_u32 m0, s47, 0
    s_add_u32 s53, s52, 368640
    buffer_load_dwordx4 v9, s[20:23], s53 offen lds
    s_add_u32 m0, s47, 1024
    s_add_u32 s53, s52, 377856
    buffer_load_dwordx4 v9, s[20:23], s53 offen lds
    s_add_u32 m0, s47, 2048
    s_add_u32 s53, s52, 387072
    buffer_load_dwordx4 v9, s[20:23], s53 offen lds
    s_add_u32 m0, s47, 3072
    s_add_u32 s53, s52, 396288
    buffer_load_dwordx4 v9, s[20:23], s53 offen lds
    s_waitcnt vmcnt(18)
    ds_read_b64_tr_b16 v[96:97], v24 offset:8192
    ds_read_b64_tr_b16 v[98:99], v24 offset:8704
    s_waitcnt lgkmcnt(8)
    v_mfma_f32_32x32x16_bf16 v[32:47], v[80:83], a[48:51], v[32:47]
    ds_read_b64_tr_b16 v[100:101], v25 offset:8192
    ds_read_b64_tr_b16 v[102:103], v25 offset:8704
    s_waitcnt lgkmcnt(8)
    v_mfma_f32_32x32x16_bf16 v[48:63], v[84:87], a[48:51], v[48:63]
    ds_read_b64_tr_b16 v[64:65], v24 offset:10240
    ds_read_b64_tr_b16 v[66:67], v24 offset:10752
    s_waitcnt lgkmcnt(8)
    v_mfma_f32_32x32x16_bf16 v[32:47], v[88:91], a[52:55], v[32:47]
    ds_read_b64_tr_b16 v[68:69], v25 offset:10240
    ds_read_b64_tr_b16 v[70:71], v25 offset:10752
    s_waitcnt lgkmcnt(8)
    v_mfma_f32_32x32x16_bf16 v[48:63], v[92:95], a[52:55], v[48:63]
    s_mov_b32 s54, 8192
    buffer_load_dwordx4 a[88:91], v8, s[16:19], s54 offen offset:3072
    s_mov_b32 s54, 8192
    buffer_load_dwordx4 a[92:95], v8, s[16:19], s54 offen offset:3584
    s_add_u32 m0, s47, 4096
    s_add_u32 s53, s52, 405504
    buffer_load_dwordx4 v9, s[20:23], s53 offen lds
    s_add_u32 m0, s47, 5120
    s_add_u32 s53, s52, 414720
    buffer_load_dwordx4 v9, s[20:23], s53 offen lds
    s_add_u32 m0, s47, 6144
    s_add_u32 s53, s52, 423936
    buffer_load_dwordx4 v9, s[20:23], s53 offen lds
    s_add_u32 m0, s47, 7168
    s_add_u32 s53, s52, 433152
    buffer_load_dwordx4 v9, s[20:23], s53 offen lds
    s_waitcnt vmcnt(18)
    ds_read_b64_tr_b16 v[72:73], v24 offset:12288
    ds_read_b64_tr_b16 v[74:75], v24 offset:12800
    s_waitcnt lgkmcnt(8)
    v_mfma_f32_32x32x16_bf16 v[32:47], v[96:99], a[56:59], v[32:47]
    ds_read_b64_tr_b16 v[76:77], v25 offset:12288
    ds_read_b64_tr_b16 v[78:79], v25 offset:12800
    s_waitcnt lgkmcnt(8)
    v_mfma_f32_32x32x16_bf16 v[48:63], v[100:103], a[56:59], v[48:63]
    ds_read_b64_tr_b16 v[80:81], v24 offset:14336
    ds_read_b64_tr_b16 v[82:83], v24 offset:14848
    s_waitcnt lgkmcnt(8)
    v_mfma_f32_32x32x16_bf16 v[32:47], v[64:67], a[60:63], v[32:47]
    ds_read_b64_tr_b16 v[84:85], v25 offset:14336
    ds_read_b64_tr_b16 v[86:87], v25 offset:14848
    s_waitcnt lgkmcnt(8)
    v_mfma_f32_32x32x16_bf16 v[48:63], v[68:71], a[60:63], v[48:63]
    s_mov_b32 s54, 12288
    buffer_load_dwordx4 a[96:99], v8, s[16:19], s54 offen offset:0
    s_mov_b32 s54, 12288
    buffer_load_dwordx4 a[100:103], v8, s[16:19], s54 offen offset:512
    s_add_u32 m0, s47, 8192
    s_add_u32 s53, s52, 442368
    buffer_load_dwordx4 v9, s[20:23], s53 offen lds
    s_add_u32 m0, s47, 9216
    s_add_u32 s53, s52, 451584
    buffer_load_dwordx4 v9, s[20:23], s53 offen lds
    s_add_u32 m0, s47, 10240
    s_add_u32 s53, s52, 460800
    buffer_load_dwordx4 v9, s[20:23], s53 offen lds
    s_add_u32 m0, s47, 11264
    s_add_u32 s53, s52, 470016
    buffer_load_dwordx4 v9, s[20:23], s53 offen lds
    s_waitcnt vmcnt(18)
    ds_read_b64_tr_b16 v[88:89], v24 offset:16384
    ds_read_b64_tr_b16 v[90:91], v24 offset:16896
    s_waitcnt lgkmcnt(8)
    v_mfma_f32_32x32x16_bf16 v[32:47], v[72:75], a[64:67], v[32:47]
    ds_read_b64_tr_b16 v[92:93], v25 offset:16384
    ds_read_b64_tr_b16 v[94:95], v25 offset:16896
    s_waitcnt lgkmcnt(8)
    v_mfma_f32_32x32x16_bf16 v[48:63], v[76:79], a[64:67], v[48:63]
    ds_read_b64_tr_b16 v[96:97], v24 offset:18432
    ds_read_b64_tr_b16 v[98:99], v24 offset:18944
    s_waitcnt lgkmcnt(8)
    v_mfma_f32_32x32x16_bf16 v[32:47], v[80:83], a[68:71], v[32:47]
    ds_read_b64_tr_b16 v[100:101], v25 offset:18432
    ds_read_b64_tr_b16 v[102:103], v25 offset:18944
    s_waitcnt lgkmcnt(8)
    v_mfma_f32_32x32x16_bf16 v[48:63], v[84:87], a[68:71], v[48:63]
    s_mov_b32 s54, 12288
    buffer_load_dwordx4 a[104:107], v8, s[16:19], s54 offen offset:1024
    s_mov_b32 s54, 12288
    buffer_load_dwordx4 a[108:111], v8, s[16:19], s54 offen offset:1536
    s_add_u32 m0, s47, 12288
    s_add_u32 s53, s52, 479232
    buffer_load_dwordx4 v9, s[20:23], s53 offen lds
    s_add_u32 m0, s47, 13312
    s_add_u32 s53, s52, 488448
    buffer_load_dwordx4 v9, s[20:23], s53 offen lds
    s_add_u32 m0, s47, 14336
    s_add_u32 s53, s52, 497664
    buffer_load_dwordx4 v9, s[20:23], s53 offen lds
    s_add_u32 m0, s47, 15360
    s_add_u32 s53, s52, 506880
    buffer_load_dwordx4 v9, s[20:23], s53 offen lds
    s_waitcnt vmcnt(18)
    ds_read_b64_tr_b16 v[64:65], v24 offset:0
    ds_read_b64_tr_b16 v[66:67], v24 offset:512
    s_waitcnt lgkmcnt(8)
    v_mfma_f32_32x32x16_bf16 v[32:47], v[88:91], a[72:75], v[32:47]
    ds_read_b64_tr_b16 v[68:69], v25 offset:0
    ds_read_b64_tr_b16 v[70:71], v25 offset:512
    s_waitcnt lgkmcnt(8)
    v_mfma_f32_32x32x16_bf16 v[48:63], v[92:95], a[72:75], v[48:63]
    ds_read_b64_tr_b16 v[72:73], v24 offset:2048
    ds_read_b64_tr_b16 v[74:75], v24 offset:2560
    s_waitcnt lgkmcnt(8)
    v_mfma_f32_32x32x16_bf16 v[32:47], v[96:99], a[76:79], v[32:47]
    ds_read_b64_tr_b16 v[76:77], v25 offset:2048
    ds_read_b64_tr_b16 v[78:79], v25 offset:2560
    s_waitcnt lgkmcnt(8)
    v_mfma_f32_32x32x16_bf16 v[48:63], v[100:103], a[76:79], v[48:63]
    s_mov_b32 s54, 12288
    buffer_load_dwordx4 a[112:115], v8, s[16:19], s54 offen offset:2048
    s_mov_b32 s54, 12288
    buffer_load_dwordx4 a[116:119], v8, s[16:19], s54 offen offset:2560
    s_add_u32 m0, s47, 16384
    s_add_u32 s53, s52, 516096
    buffer_load_dwordx4 v9, s[20:23], s53 offen lds
    s_add_u32 m0, s47, 17408
    s_add_u32 s53, s52, 525312
    buffer_load_dwordx4 v9, s[20:23], s53 offen lds
    s_add_u32 m0, s47, 18432
    s_add_u32 s53, s52, 534528
    buffer_load_dwordx4 v9, s[20:23], s53 offen lds
    s_add_u32 m0, s47, 19456
    s_add_u32 s53, s52, 543744
    buffer_load_dwordx4 v9, s[20:23], s53 offen lds
    s_waitcnt vmcnt(18)
    ds_read_b64_tr_b16 v[80:81], v24 offset:4096
    ds_read_b64_tr_b16 v[82:83], v24 offset:4608
    s_waitcnt lgkmcnt(8)
    v_mfma_f32_32x32x16_bf16 v[32:47], v[64:67], a[80:83], v[32:47]
    ds_read_b64_tr_b16 v[84:85], v25 offset:4096
    ds_read_b64_tr_b16 v[86:87], v25 offset:4608
    s_waitcnt lgkmcnt(8)
    v_mfma_f32_32x32x16_bf16 v[48:63], v[68:71], a[80:83], v[48:63]
    ds_read_b64_tr_b16 v[88:89], v24 offset:6144
    ds_read_b64_tr_b16 v[90:91], v24 offset:6656
    s_waitcnt lgkmcnt(8)
    v_mfma_f32_32x32x16_bf16 v[32:47], v[72:75], a[84:87], v[32:47]
    ds_read_b64_tr_b16 v[92:93], v25 offset:6144
    ds_read_b64_tr_b16 v[94:95], v25 offset:6656
    s_waitcnt lgkmcnt(8)
    v_mfma_f32_32x32x16_bf16 v[48:63], v[76:79], a[84:87], v[48:63]
    s_mov_b32 s54, 12288
    buffer_load_dwordx4 a[120:123], v8, s[16:19], s54 offen offset:3072
    s_mov_b32 s54, 12288
    buffer_load_dwordx4 a[124:127], v8, s[16:19], s54 offen offset:3584
    s_add_u32 m0, s47, 0
    s_add_u32 s53, s52, 552960
    buffer_load_dwordx4 v9, s[20:23], s53 offen lds
    s_add_u32 m0, s47, 1024
    s_add_u32 s53, s52, 562176
    buffer_load_dwordx4 v9, s[20:23], s53 offen lds
    s_add_u32 m0, s47, 2048
    s_add_u32 s53, s52, 571392
    buffer_load_dwordx4 v9, s[20:23], s53 offen lds
    s_add_u32 m0, s47, 3072
    s_add_u32 s53, s52, 580608
    buffer_load_dwordx4 v9, s[20:23], s53 offen lds
    s_waitcnt vmcnt(18)
    ds_read_b64_tr_b16 v[96:97], v24 offset:8192
    ds_read_b64_tr_b16 v[98:99], v24 offset:8704
    s_waitcnt lgkmcnt(8)
    v_mfma_f32_32x32x16_bf16 v[32:47], v[80:83], a[88:91], v[32:47]
    ds_read_b64_tr_b16 v[100:101], v25 offset:8192
    ds_read_b64_tr_b16 v[102:103], v25 offset:8704
    s_waitcnt lgkmcnt(8)
    v_mfma_f32_32x32x16_bf16 v[48:63], v[84:87], a[88:91], v[48:63]
    ds_read_b64_tr_b16 v[64:65], v24 offset:10240
    ds_read_b64_tr_b16 v[66:67], v24 offset:10752
    s_waitcnt lgkmcnt(8)
    v_mfma_f32_32x32x16_bf16 v[32:47], v[88:91], a[92:95], v[32:47]
    ds_read_b64_tr_b16 v[68:69], v25 offset:10240
    ds_read_b64_tr_b16 v[70:71], v25 offset:10752
    s_waitcnt lgkmcnt(8)
    v_mfma_f32_32x32x16_bf16 v[48:63], v[92:95], a[92:95], v[48:63]
    s_waitcnt vmcnt(12)
    ds_read_b64_tr_b16 v[72:73], v24 offset:12288
    ds_read_b64_tr_b16 v[74:75], v24 offset:12800
    s_waitcnt lgkmcnt(8)
    v_mfma_f32_32x32x16_bf16 v[32:47], v[96:99], a[96:99], v[32:47]
    ds_read_b64_tr_b16 v[76:77], v25 offset:12288
    ds_read_b64_tr_b16 v[78:79], v25 offset:12800
    s_waitcnt lgkmcnt(8)
    v_mfma_f32_32x32x16_bf16 v[48:63], v[100:103], a[96:99], v[48:63]
    ds_read_b64_tr_b16 v[80:81], v24 offset:14336
    ds_read_b64_tr_b16 v[82:83], v24 offset:14848
    s_waitcnt lgkmcnt(8)
    v_mfma_f32_32x32x16_bf16 v[32:47], v[64:67], a[100:103], v[32:47]
    ds_read_b64_tr_b16 v[84:85], v25 offset:14336
    ds_read_b64_tr_b16 v[86:87], v25 offset:14848
    s_waitcnt lgkmcnt(8)
    v_mfma_f32_32x32x16_bf16 v[48:63], v[68:71], a[100:103], v[48:63]
    s_waitcnt vmcnt(6)
    ds_read_b64_tr_b16 v[88:89], v24 offset:16384
    ds_read_b64_tr_b16 v[90:91], v24 offset:16896
    s_waitcnt lgkmcnt(8)
    v_mfma_f32_32x32x16_bf16 v[32:47], v[72:75], a[104:107], v[32:47]
    ds_read_b64_tr_b16 v[92:93], v25 offset:16384
    ds_read_b64_tr_b16 v[94:95], v25 offset:16896
    s_waitcnt lgkmcnt(8)
    v_mfma_f32_32x32x16_bf16 v[48:63], v[76:79], a[104:107], v[48:63]
    ds_read_b64_tr_b16 v[96:97], v24 offset:18432
    ds_read_b64_tr_b16 v[98:99], v24 offset:18944
    s_waitcnt lgkmcnt(8)
    v_mfma_f32_32x32x16_bf16 v[32:47], v[80:83], a[108:111], v[32:47]
    ds_read_b64_tr_b16 v[100:101], v25 offset:18432
    ds_read_b64_tr_b16 v[102:103], v25 offset:18944
    s_waitcnt lgkmcnt(8)
    v_mfma_f32_32x32x16_bf16 v[48:63], v[84:87], a[108:111], v[48:63]
    s_waitcnt vmcnt(0)
    ds_read_b64_tr_b16 v[64:65], v24 offset:0
    ds_read_b64_tr_b16 v[66:67], v24 offset:512
    s_waitcnt lgkmcnt(8)
    v_mfma_f32_32x32x16_bf16 v[32:47], v[88:91], a[112:115], v[32:47]
    ds_read_b64_tr_b16 v[68:69], v25 offset:0
    ds_read_b64_tr_b16 v[70:71], v25 offset:512
    s_waitcnt lgkmcnt(8)
    v_mfma_f32_32x32x16_bf16 v[48:63], v[92:95], a[112:115], v[48:63]
    ds_read_b64_tr_b16 v[72:73], v24 offset:2048
    ds_read_b64_tr_b16 v[74:75], v24 offset:2560
    s_waitcnt lgkmcnt(8)
    v_mfma_f32_32x32x16_bf16 v[32:47], v[96:99], a[116:119], v[32:47]
    ds_read_b64_tr_b16 v[76:77], v25 offset:2048
    ds_read_b64_tr_b16 v[78:79], v25 offset:2560
    s_waitcnt lgkmcnt(8)
    v_mfma_f32_32x32x16_bf16 v[48:63], v[100:103], a[116:119], v[48:63]
    s_waitcnt lgkmcnt(6)
    v_mfma_f32_32x32x16_bf16 v[32:47], v[64:67], a[120:123], v[32:47]
    s_waitcnt lgkmcnt(4)
    v_mfma_f32_32x32x16_bf16 v[48:63], v[68:71], a[120:123], v[48:63]
    s_waitcnt lgkmcnt(2)
    v_mfma_f32_32x32x16_bf16 v[32:47], v[72:75], a[124:127], v[32:47]
    s_waitcnt lgkmcnt(0)
    v_mfma_f32_32x32x16_bf16 v[48:63], v[76:79], a[124:127], v[48:63]
    s_barrier
    s_nop 7
    v_lshlrev_b32 v2, 4, v1
    s_lshl_b32 s54, s46, 13
    v_add_u32 v3, s54, v2
    ds_write_b128 v3, v[32:35] offset:0
    ds_write_b128 v3, v[36:39] offset:1024
    ds_write_b128 v3, v[40:43] offset:2048
    ds_write_b128 v3, v[44:47] offset:3072
    ds_write_b128 v3, v[48:51] offset:4096
    ds_write_b128 v3, v[52:55] offset:5120
    ds_write_b128 v3, v[56:59] offset:6144
    ds_write_b128 v3, v[60:63] offset:7168
    s_waitcnt lgkmcnt(0)
    s_barrier
    s_lshl_b32 s54, s46, 10
    v_add_u32 v3, s54, v2
    ds_read_b128 v[64:67], v3 offset:0
    ds_read_b128 v[68:71], v3 offset:8192
    ds_read_b128 v[72:75], v3 offset:16384
    ds_read_b128 v[76:79], v3 offset:24576
    ds_read_b128 v[80:83], v3 offset:32768
    ds_read_b128 v[84:87], v3 offset:40960
    ds_read_b128 v[88:91], v3 offset:49152
    ds_read_b128 v[92:95], v3 offset:57344
    v_and_b32 v3, 31, v1
    s_lshl_b32 s55, s44, 5
    v_add_u32 v5, s55, v3
    v_mul_u32_u24 v5, 1152, v5
    v_lshl_add_u32 v5, v4, 4, v5
    s_lshr_b32 s55, s46, 1
    s_lshl_b32 s55, s55, 5
    s_and_b32 s56, s46, 1
    s_lshl_b32 s56, s56, 3
    s_add_u32 s55, s55, s56
    s_add_u32 s55, s55, s51
    v_add_u32 v5, s55, v5
    s_waitcnt lgkmcnt(0)
    v_add_f32 v64, v64, v80
    v_add_f32 v65, v65, v81
    v_add_f32 v66, v66, v82
    v_add_f32 v67, v67, v83
    v_add_f32 v68, v68, v84
    v_add_f32 v69, v69, v85
    v_add_f32 v70, v70, v86
    v_add_f32 v71, v71, v87
    v_add_f32 v72, v72, v88
    v_add_f32 v73, v73, v89
    v_add_f32 v74, v74, v90
    v_add_f32 v75, v75, v91
    v_add_f32 v76, v76, v92
    v_add_f32 v77, v77, v93
    v_add_f32 v78, v78, v94
    v_add_f32 v79, v79, v95
    v_add_f32 v64, v64, v72
    v_add_f32 v65, v65, v73
    v_add_f32 v66, v66, v74
    v_add_f32 v67, v67, v75
    v_add_f32 v68, v68, v76
    v_add_f32 v69, v69, v77
    v_add_f32 v70, v70, v78
    v_add_f32 v71, v71, v79
    v_add_f32 v64, v64, v68
    v_add_f32 v65, v65, v69
    v_add_f32 v66, v66, v70
    v_add_f32 v67, v67, v71
    v_cvt_pk_bf16_f32 v96, v64, v65
    v_cvt_pk_bf16_f32 v97, v66, v67
    buffer_store_dwordx2 v[96:97], v5, s[24:27], 0 offen
K2_END:
    s_endpgm

.section .rodata,"a"
.p2align 6
.amdhsa_kernel attn_fused_kernel
  .amdhsa_next_free_vgpr 256
  .amdhsa_next_free_sgpr 102
  .amdhsa_accum_offset 128
  .amdhsa_group_segment_fixed_size 0
  .amdhsa_kernarg_size 64
  .amdhsa_user_sgpr_count 2
  .amdhsa_user_sgpr_kernarg_segment_ptr 1
  .amdhsa_system_sgpr_workgroup_id_x 1
.end_amdhsa_kernel
.text

.section .rodata,"a"
.p2align 6
.amdhsa_kernel oproj_kernel
  .amdhsa_next_free_vgpr 256
  .amdhsa_next_free_sgpr 102
  .amdhsa_accum_offset 128
  .amdhsa_group_segment_fixed_size 0
  .amdhsa_kernarg_size 64
  .amdhsa_user_sgpr_count 2
  .amdhsa_user_sgpr_kernarg_segment_ptr 1
  .amdhsa_system_sgpr_workgroup_id_x 1
.end_amdhsa_kernel
.text
```
